```python
import torch

def _softmax(x, axis=-1):
    return torch.softmax(x, dim=axis)
def _gelu(x):
    return torch.nn.functional.gelu(x, approximate="tanh")
def _silu(x):
    return torch.nn.functional.silu(x)
def _sigmoid(x):
    return torch.sigmoid(x)
def _layernorm(x, axis=-1, eps=1e-5):
    m = x.mean(dim=axis, keepdim=True)
    v = x.var(dim=axis, keepdim=True, unbiased=False)
    return (x - m) / torch.sqrt(v + eps)
def _scatter_add(tgt, idx, src, axis=0):
    return tgt.clone().index_add_(axis, idx, src)
def _segment_sum(src, seg, n):
    out = torch.zeros((n,) + src.shape[1:], dtype=src.dtype)
    return out.index_add_(0, seg, src)
def _pad(x, pw):
    flat = tuple(v for pair in reversed(pw) for v in pair)
    return torch.nn.functional.pad(x, flat)

kernel_name = 'concat_heads__mha_block_cached__gqa_block_cached__decode'

def setup_inputs():

    _w = (lambda a: (lambda t: t.to(torch.bfloat16) if t.is_floating_point() else t)(torch.as_tensor(a)))
    def _A_setup():
        B, Sq, D = 1, 1, 576
        H, Sk, Dh = 32, 65536, 128
        return {
            "x": _w((lambda *s: torch.randn(*s, dtype=torch.bfloat16) * 0.8)(B, Sq, D)),
            "k_cache": _w((lambda *s: torch.randn(*s, dtype=torch.bfloat16) * 1.6)(B, H, Sk, Dh)),
            "v_cache": _w((lambda *s: torch.randn(*s, dtype=torch.bfloat16) * 0.2)(B, H, Sk, Dh)),
            "wq": _w((lambda *s: torch.randn(*s, dtype=torch.bfloat16) * 1.6)(D, H * Dh) * (D ** -0.5)),
            "wo": _w((lambda *s: torch.randn(*s, dtype=torch.bfloat16) * 0.2)(H * Dh, D) * ((H * Dh) ** -0.5)),
        }
    _A_in = _A_setup()

    def _B_setup():
        B, Sq, D = 1, 1, 576
        Hq, Hkv, Sk, Dh = 32, 16, 65536, 128
        assert Hq % Hkv == 0, (Hq, Hkv)
        return {
            "x": _w((lambda *s: torch.randn(*s, dtype=torch.bfloat16) * 0.8)(B, Sq, D)),
            "k_cache": _w((lambda *s: torch.randn(*s, dtype=torch.bfloat16) * 1.6)(B, Hkv, Sk, Dh)),
            "v_cache": _w((lambda *s: torch.randn(*s, dtype=torch.bfloat16) * 0.2)(B, Hkv, Sk, Dh)),
            "wq": _w((lambda *s: torch.randn(*s, dtype=torch.bfloat16) * 1.6)(D, Hq * Dh) * (D ** -0.5)),
            "wo": _w((lambda *s: torch.randn(*s, dtype=torch.bfloat16) * 0.2)(Hq * Dh, D) * ((Hq * Dh) ** -0.5)),
        }
    _B_in = _B_setup()

    return {
        "A_x": _A_in["x"],
        "A_k_cache": _A_in["k_cache"],
        "A_v_cache": _A_in["v_cache"],
        "A_wq": _A_in["wq"],
        "A_wo": _A_in["wo"],
        "B_x": _B_in["x"],
        "B_k_cache": _B_in["k_cache"],
        "B_v_cache": _B_in["v_cache"],
        "B_wq": _B_in["wq"],
        "B_wo": _B_in["wo"],
    }

def reference(A_x, A_k_cache, A_v_cache, A_wq, A_wo, B_x, B_k_cache, B_v_cache, B_wq, B_wo):
    def _A_ref(x, k_cache, v_cache, wq, wo):
        B, Sq, D = x.shape
        H, Dh = 32, 128
        q = (lambda x, *d: x.permute(*d))((x @ wq).reshape(B, Sq, H, Dh), 0, 2, 1, 3)
        scores = torch.einsum("bhqd,bhkd->bhqk", q, k_cache) * (Dh ** -0.5)
        p = _softmax(scores, axis=-1)
        o = torch.einsum("bhqk,bhkd->bhqd", p, v_cache)
        return (lambda x, *d: x.permute(*d))(o, 0, 2, 1, 3).reshape(B, Sq, H * Dh) @ wo

    def _B_ref(x, k_cache, v_cache, wq, wo):
        B, Sq, D = x.shape
        Hq, Dh = 32, 128
        Hkv = k_cache.shape[1]
        rep = Hq // Hkv
        q = (lambda x, *d: x.permute(*d))((x @ wq).reshape(B, Sq, Hq, Dh), 0, 2, 1, 3)
        k = (lambda x, n, axis: torch.repeat_interleave(x, n, dim=axis))(k_cache, rep, axis=1)
        v = (lambda x, n, axis: torch.repeat_interleave(x, n, dim=axis))(v_cache, rep, axis=1)
        scores = torch.einsum("bhqd,bhkd->bhqk", q, k) * (Dh ** -0.5)
        p = _softmax(scores, axis=-1)
        o = torch.einsum("bhqk,bhkd->bhqd", p, v)
        return (lambda x, *d: x.permute(*d))(o, 0, 2, 1, 3).reshape(B, Sq, Hq * Dh) @ wo

    a = _A_ref(A_x, A_k_cache, A_v_cache, A_wq, A_wo)
    b = _B_ref(B_x, B_k_cache, B_v_cache, B_wq, B_wo)
    return torch.concatenate([a, b], axis=-1)
```

```asm
; @launch grid=(256,1,1) block=(256,1,1) lds=33792
.amdgcn_target "amdgcn-amd-amdhsa--gfx950"
.text
.globl concat_heads__mha_block_cached__gqa_block_cached__decode_kernel
.p2align 8
.type concat_heads__mha_block_cached__gqa_block_cached__decode_kernel,@function
concat_heads__mha_block_cached__gqa_block_cached__decode_kernel:
s_cmp_ge_u32 s2, 256
s_cbranch_scc1 L_end
s_load_dwordx16 s[40:55], s[0:1], 0
s_load_dwordx8 s[56:63], s[0:1], 64
s_load_dwordx2 s[64:65], s[0:1], 96
v_lshrrev_b32 v1, 6, v0
v_and_b32 v0, 63, v0
v_and_b32 v2, 15, v0
v_readfirstlane_b32 s3, v1
v_lshrrev_b32 v3, 4, v0
v_lshlrev_b32 v5, 4, v0
s_lshr_b32 s34, s2, 3
s_lshr_b32 s35, s2, 4
s_add_u32 s35, s35, 32
s_lshl_b32 s28, s3, 12
s_lshl_b32 s27, s2, 20
s_add_u32 s27, s27, s28
s_lshl_b32 s92, s2, 21
s_add_u32 s92, s92, s28
v_and_b32 v4, 3, v0
v_lshlrev_b32 v4, 4, v4
v_bfe_u32 v14, v0, 2, 2
v_lshl_add_u32 v4, v14, 8, v4
v_lshl_add_u32 v4, v3, 6, v4
s_waitcnt lgkmcnt(0)
s_cmp_eq_u32 s3, 3
s_cbranch_scc1 L_helper
s_mov_b32 s4, s42
s_and_b32 s5, s43, 0xffff
s_mov_b32 s8, s44
s_and_b32 s9, s45, 0xffff
s_mov_b32 s40, s52
s_and_b32 s41, s53, 0xffff
s_mov_b32 s42, 0x10000000
s_mov_b32 s43, 0x20000
buffer_load_dwordx4 a[0:3], v4, s[40:43], s27 offen offset:0 nt
buffer_load_dwordx4 a[4:7], v4, s[40:43], s27 offen offset:1024 nt
buffer_load_dwordx4 a[8:11], v4, s[40:43], s27 offen offset:2048 nt
buffer_load_dwordx4 a[12:15], v4, s[40:43], s27 offen offset:3072 nt
s_add_u32 s29, s27, 12288
buffer_load_dwordx4 a[16:19], v4, s[40:43], s29 offen offset:0 nt
buffer_load_dwordx4 a[20:23], v4, s[40:43], s29 offen offset:1024 nt
buffer_load_dwordx4 a[24:27], v4, s[40:43], s29 offen offset:2048 nt
s_mov_b32 s6, 0x20000000
s_mov_b32 s7, 0x20000
s_mov_b32 s10, s6
s_mov_b32 s11, 0x20000
s_mov_b32 s44, s54
s_and_b32 s45, s55, 0xffff
s_mov_b32 s46, s42
s_mov_b32 s47, 0x20000
v_and_b32 v14, 1, v0
v_lshlrev_b32 v14, 4, v14
v_mov_b32 v15, 0xffff
v_lshlrev_b32 v14, v14, v15
v_bfe_u32 v15, v0, 1, 2
v_cmp_eq_u32 vcc, 0, v15
s_nop 1
v_cndmask_b32 v8, 0, v14, vcc
v_cmp_eq_u32 vcc, 1, v15
s_nop 1
v_cndmask_b32 v9, 0, v14, vcc
v_cmp_eq_u32 vcc, 2, v15
s_nop 1
v_cndmask_b32 v10, 0, v14, vcc
v_cmp_eq_u32 vcc, 3, v15
s_nop 1
v_cndmask_b32 v11, 0, v14, vcc
s_mov_b32 s66, 0x01000100
s_mov_b32 s67, 0x03020302
s_mov_b32 s12, s64
s_and_b32 s13, s65, 0xffff
s_mov_b32 s14, 1376256
s_mov_b32 s15, 0x20000
s_mov_b32 s18, 4718592
s_mov_b32 s19, 0x20000
s_mov_b32 s23, 0x20000
s_mov_b32 s95, 131072
s_mov_b32 s94, 0
s_lshl_b32 s39, s34, 24
s_add_u32 s39, s39, 1966080
s_and_b32 s38, s35, 31
s_lshl_b32 s38, s38, 24
s_add_u32 s38, s38, 983040
s_and_b32 s24, s2, 7
s_mul_i32 s25, s24, 3
s_add_u32 s25, s25, s3
s_mul_i32 s28, s25, 4096
s_lshr_b32 s28, s28, 16
s_mul_i32 s29, s28, 1966080
s_lshl_b32 s28, s25, 13
s_add_u32 s28, s28, s29
s_add_u32 s86, s28, s39
s_and_b32 s26, s2, 15
s_mul_i32 s25, s26, 3
s_add_u32 s25, s25, s3
s_mul_i32 s28, s25, 8192
s_lshr_b32 s28, s28, 16
s_mul_i32 s29, s28, 983040
s_lshl_b32 s28, s25, 13
s_add_u32 s28, s28, s29
s_add_u32 s84, s28, s38
s_lshl_b32 s87, s34, 4
s_add_u32 s87, s87, s24
s_lshl_b32 s28, s35, 5
s_sub_u32 s28, s28, 512
s_add_u32 s28, s28, s26
s_cmp_eq_u32 s3, 2
s_cselect_b32 s87, s28, s87
s_cselect_b64 s[88:89], -1, 0
s_or_b32 s88, s88, 0x00ff00ff
s_or_b32 s89, s89, 0x00ff00ff
v_lshrrev_b32 v14, 3, v2
v_lshlrev_b32 v14, 13, v14
v_and_b32 v15, 7, v0
v_lshl_add_u32 v15, v3, 3, v15
v_lshl_add_u32 v63, v15, 4, v14
s_cmp_eq_u32 s3, 0
s_cbranch_scc1 L_ncl
v_mov_b32 v56, -1
v_mov_b32 v57, -1
v_mov_b32 v58, -1
v_mov_b32 v59, -1
s_lshl_b32 s28, s87, 9
s_add_u32 s28, s28, 262144
s_mov_b64 exec, s[88:89]
buffer_store_dwordx4 v[56:59], v63, s[12:15], s28 offen sc1
s_mov_b64 exec, -1
L_ncl:
s_waitcnt vmcnt(6)
s_add_u32 s29, s27, 12288
buffer_load_dwordx4 a[28:31], v4, s[40:43], s29 offen offset:3072 nt
s_waitcnt vmcnt(6)
s_add_u32 s29, s27, 24576
buffer_load_dwordx4 a[32:35], v4, s[40:43], s29 offen offset:0 nt
s_waitcnt vmcnt(6)
buffer_load_dwordx4 a[36:39], v4, s[40:43], s29 offen offset:1024 nt
s_waitcnt vmcnt(6)
buffer_load_dwordx4 a[40:43], v4, s[40:43], s29 offen offset:2048 nt
s_waitcnt vmcnt(6)
buffer_load_dwordx4 a[44:47], v4, s[40:43], s29 offen offset:3072 nt
s_waitcnt vmcnt(6)
s_add_u32 s29, s27, 36864
buffer_load_dwordx4 a[48:51], v4, s[40:43], s29 offen offset:0 nt
s_waitcnt vmcnt(6)
buffer_load_dwordx4 a[52:55], v4, s[40:43], s29 offen offset:1024 nt
s_waitcnt vmcnt(6)
buffer_load_dwordx4 a[56:59], v4, s[40:43], s29 offen offset:2048 nt
s_waitcnt vmcnt(6)
buffer_load_dwordx4 a[60:63], v4, s[40:43], s29 offen offset:3072 nt
s_waitcnt vmcnt(6)
s_add_u32 s29, s27, 49152
buffer_load_dwordx4 a[64:67], v4, s[40:43], s29 offen offset:0 nt
s_waitcnt vmcnt(6)
buffer_load_dwordx4 a[68:71], v4, s[40:43], s29 offen offset:1024 nt
s_waitcnt vmcnt(6)
buffer_load_dwordx4 a[72:75], v4, s[40:43], s29 offen offset:2048 nt
s_waitcnt vmcnt(6)
buffer_load_dwordx4 a[76:79], v4, s[40:43], s29 offen offset:3072 nt
s_waitcnt vmcnt(6)
s_add_u32 s29, s27, 61440
buffer_load_dwordx4 a[80:83], v4, s[40:43], s29 offen offset:0 nt
s_waitcnt vmcnt(6)
buffer_load_dwordx4 a[84:87], v4, s[40:43], s29 offen offset:1024 nt
s_waitcnt vmcnt(6)
buffer_load_dwordx4 a[88:91], v4, s[40:43], s29 offen offset:2048 nt
s_waitcnt vmcnt(6)
buffer_load_dwordx4 a[92:95], v4, s[40:43], s29 offen offset:3072 nt
s_waitcnt vmcnt(6)
s_add_u32 s29, s27, 73728
buffer_load_dwordx4 a[96:99], v4, s[40:43], s29 offen offset:0 nt
s_waitcnt vmcnt(6)
buffer_load_dwordx4 a[100:103], v4, s[40:43], s29 offen offset:1024 nt
s_waitcnt vmcnt(6)
buffer_load_dwordx4 a[104:107], v4, s[40:43], s29 offen offset:2048 nt
s_waitcnt vmcnt(6)
buffer_load_dwordx4 a[108:111], v4, s[40:43], s29 offen offset:3072 nt
s_waitcnt vmcnt(6)
s_add_u32 s29, s27, 86016
buffer_load_dwordx4 a[112:115], v4, s[40:43], s29 offen offset:0 nt
s_waitcnt vmcnt(6)
buffer_load_dwordx4 a[116:119], v4, s[40:43], s29 offen offset:1024 nt
s_waitcnt vmcnt(6)
buffer_load_dwordx4 a[120:123], v4, s[40:43], s29 offen offset:2048 nt
s_waitcnt vmcnt(6)
buffer_load_dwordx4 a[124:127], v4, s[40:43], s29 offen offset:3072 nt
s_waitcnt vmcnt(6)
s_add_u32 s29, s27, 98304
buffer_load_dwordx4 a[128:131], v4, s[40:43], s29 offen offset:0 nt
s_waitcnt vmcnt(6)
buffer_load_dwordx4 a[132:135], v4, s[40:43], s29 offen offset:1024 nt
s_waitcnt vmcnt(6)
buffer_load_dwordx4 a[136:139], v4, s[40:43], s29 offen offset:2048 nt
s_waitcnt vmcnt(6)
buffer_load_dwordx4 a[140:143], v4, s[40:43], s29 offen offset:3072 nt
s_waitcnt vmcnt(6)
s_add_u32 s29, s27, 110592
buffer_load_dwordx4 a[144:147], v4, s[40:43], s29 offen offset:0 nt
s_waitcnt vmcnt(6)
buffer_load_dwordx4 a[148:151], v4, s[40:43], s29 offen offset:1024 nt
s_waitcnt vmcnt(6)
buffer_load_dwordx4 a[152:155], v4, s[40:43], s29 offen offset:2048 nt
s_waitcnt vmcnt(6)
buffer_load_dwordx4 a[156:159], v4, s[40:43], s29 offen offset:3072 nt
s_waitcnt vmcnt(6)
s_add_u32 s29, s27, 122880
buffer_load_dwordx4 a[160:163], v4, s[40:43], s29 offen offset:0 nt
s_waitcnt vmcnt(6)
buffer_load_dwordx4 a[164:167], v4, s[40:43], s29 offen offset:1024 nt
s_waitcnt vmcnt(6)
buffer_load_dwordx4 a[168:171], v4, s[40:43], s29 offen offset:2048 nt
s_waitcnt vmcnt(6)
buffer_load_dwordx4 a[172:175], v4, s[40:43], s29 offen offset:3072 nt
s_waitcnt vmcnt(6)
s_add_u32 s29, s27, 135168
buffer_load_dwordx4 a[176:179], v4, s[40:43], s29 offen offset:0 nt
s_waitcnt vmcnt(6)
buffer_load_dwordx4 a[180:183], v4, s[40:43], s29 offen offset:1024 nt
s_waitcnt vmcnt(6)
buffer_load_dwordx4 a[184:187], v4, s[40:43], s29 offen offset:2048 nt
s_waitcnt vmcnt(6)
buffer_load_dwordx4 a[188:191], v4, s[40:43], s29 offen offset:3072 nt
s_waitcnt vmcnt(6)
s_add_u32 s29, s27, 147456
buffer_load_dwordx4 a[192:195], v4, s[40:43], s29 offen offset:0 nt
s_waitcnt vmcnt(6)
buffer_load_dwordx4 a[196:199], v4, s[40:43], s29 offen offset:1024 nt
s_waitcnt vmcnt(6)
buffer_load_dwordx4 a[200:203], v4, s[40:43], s29 offen offset:2048 nt
s_waitcnt vmcnt(6)
buffer_load_dwordx4 a[204:207], v4, s[40:43], s29 offen offset:3072 nt
s_waitcnt vmcnt(6)
s_add_u32 s29, s27, 159744
buffer_load_dwordx4 a[208:211], v4, s[40:43], s29 offen offset:0 nt
s_waitcnt vmcnt(6)
buffer_load_dwordx4 a[212:215], v4, s[40:43], s29 offen offset:1024 nt
s_waitcnt vmcnt(6)
buffer_load_dwordx4 a[216:219], v4, s[40:43], s29 offen offset:2048 nt
s_waitcnt vmcnt(6)
buffer_load_dwordx4 a[220:223], v4, s[40:43], s29 offen offset:3072 nt
s_mov_b32 s68, 0x3fb8aa3b
s_mov_b32 s69, 0x3db504f3
s_mul_i32 s93, s3, 10496
s_add_u32 s93, s93, 2304
v_lshrrev_b32 v174, 2, v0
v_lshl_add_u32 v174, v174, 2, s93
v_mov_b32 v172, v174
v_mov_b32 v7, 0xff800000
v_mov_b32 v173, v4
s_mov_b32 s96, s40
s_mov_b32 s97, s41
s_mov_b32 s98, s42
s_mov_b32 s99, 0x20000
s_mov_b32 s83, s27
s_mov_b32 s91, 12288
v_mov_b32 v6, 0
v_mov_b32 v56, 0
v_mov_b32 v57, 0
v_mov_b32 v58, 0
v_mov_b32 v59, 0
s_lshl_b32 s28, s34, 8
s_add_u32 s28, s28, 802816
v_mov_b32 v138, s28
v_mov_b32 v52, 0
v_mov_b32 v48, 0
v_mov_b32 v49, 0
v_mov_b32 v50, 0
v_mov_b32 v51, 0
s_lshl_b32 s28, s35, 8
s_add_u32 s28, s28, 802816
v_mov_b32 v139, s28
s_barrier
v_and_b32 v14, 3, v0
v_lshl_add_u32 v14, v3, 2, v14
v_lshlrev_b32 v14, 4, v14
v_lshrrev_b32 v15, 3, v2
v_lshl_add_u32 v15, v15, 8, v14
v_mov_b32 v60, 1024
ds_read_b128 v[128:131], v14
ds_read_b128 v[132:135], v15 offset:256
ds_read_b32 v60, v60
s_waitcnt lgkmcnt(0)
v_readfirstlane_b32 s31, v60
v_bfe_u32 v14, v0, 2, 1
v_cmp_eq_u32 vcc, 0, v14
s_nop 1
v_cndmask_b32 v40, 0, v132, vcc
v_cndmask_b32 v41, 0, v133, vcc
v_cndmask_b32 v42, 0, v134, vcc
v_cndmask_b32 v43, 0, v135, vcc
v_cmp_eq_u32 vcc, 1, v14
s_nop 1
v_cndmask_b32 v44, 0, v132, vcc
v_cndmask_b32 v45, 0, v133, vcc
v_cndmask_b32 v46, 0, v134, vcc
v_cndmask_b32 v47, 0, v135, vcc
v_bfe_u32 v14, v0, 2, 2
v_cmp_eq_u32 vcc, 0, v14
s_nop 1
v_cndmask_b32 v16, 0, v128, vcc
v_cndmask_b32 v17, 0, v129, vcc
v_cndmask_b32 v18, 0, v130, vcc
v_cndmask_b32 v19, 0, v131, vcc
v_cmp_eq_u32 vcc, 1, v14
s_nop 1
v_cndmask_b32 v20, 0, v128, vcc
v_cndmask_b32 v21, 0, v129, vcc
v_cndmask_b32 v22, 0, v130, vcc
v_cndmask_b32 v23, 0, v131, vcc
v_cmp_eq_u32 vcc, 2, v14
s_nop 1
v_cndmask_b32 v24, 0, v128, vcc
v_cndmask_b32 v25, 0, v129, vcc
v_cndmask_b32 v26, 0, v130, vcc
v_cndmask_b32 v27, 0, v131, vcc
v_cmp_eq_u32 vcc, 3, v14
s_nop 1
v_cndmask_b32 v28, 0, v128, vcc
v_cndmask_b32 v29, 0, v129, vcc
v_cndmask_b32 v30, 0, v130, vcc
v_cndmask_b32 v31, 0, v131, vcc
s_and_b32 s90, s31, 0xfffff000
s_waitcnt vmcnt(6)
s_add_u32 s29, s27, 172032
buffer_load_dwordx4 a[224:227], v4, s[40:43], s29 offen offset:0 nt
v_mfma_f32_16x16x32_bf16 v[32:35], a[0:3], v[40:43], 0
v_mfma_f32_16x16x32_bf16 v[32:35], a[4:7], v[44:47], v[32:35]
v_mfma_f32_16x16x32_bf16 v[36:39], a[8:11], v[40:43], 0
v_mfma_f32_16x16x32_bf16 v[36:39], a[12:15], v[44:47], v[36:39]
s_nop 5
v_mov_b32_dpp v61, v32 quad_perm:[0,0,0,0] row_mask:0xf bank_mask:0xf
s_nop 1
v_add_f32_dpp v61, v33, v61 quad_perm:[1,1,1,1] row_mask:0xf bank_mask:0xf
s_nop 1
v_add_f32_dpp v61, v34, v61 quad_perm:[2,2,2,2] row_mask:0xf bank_mask:0xf
s_nop 1
v_add_f32_dpp v61, v35, v61 quad_perm:[3,3,3,3] row_mask:0xf bank_mask:0xf
v_cvt_pk_bf16_f32 v61, v61, v61
v_and_b32 v61, 0xffff0000, v61
v_mul_f32 v61, s69, v61
v_cvt_pk_bf16_f32 v61, v61, v61
v_and_b32 v61, 0xffff0000, v61
v_max_f32 v7, v7, v61
ds_write_b32 v172, v61 offset:64
s_waitcnt vmcnt(6)
buffer_load_dwordx4 a[228:231], v4, s[40:43], s29 offen offset:1024 nt
v_mfma_f32_16x16x32_bf16 v[32:35], a[16:19], v[40:43], 0
v_mfma_f32_16x16x32_bf16 v[32:35], a[20:23], v[44:47], v[32:35]
s_nop 5
v_mov_b32_dpp v61, v36 quad_perm:[0,0,0,0] row_mask:0xf bank_mask:0xf
s_nop 1
v_add_f32_dpp v61, v37, v61 quad_perm:[1,1,1,1] row_mask:0xf bank_mask:0xf
s_nop 1
v_add_f32_dpp v61, v38, v61 quad_perm:[2,2,2,2] row_mask:0xf bank_mask:0xf
s_nop 1
v_add_f32_dpp v61, v39, v61 quad_perm:[3,3,3,3] row_mask:0xf bank_mask:0xf
v_cvt_pk_bf16_f32 v61, v61, v61
v_and_b32 v61, 0xffff0000, v61
v_mul_f32 v61, s69, v61
v_cvt_pk_bf16_f32 v61, v61, v61
v_and_b32 v61, 0xffff0000, v61
v_max_f32 v7, v7, v61
ds_write_b32 v172, v61 offset:128
v_mfma_f32_16x16x32_bf16 v[36:39], a[24:27], v[40:43], 0
v_mfma_f32_16x16x32_bf16 v[36:39], a[28:31], v[44:47], v[36:39]
s_nop 5
v_mov_b32_dpp v61, v32 quad_perm:[0,0,0,0] row_mask:0xf bank_mask:0xf
s_nop 1
v_add_f32_dpp v61, v33, v61 quad_perm:[1,1,1,1] row_mask:0xf bank_mask:0xf
s_nop 1
v_add_f32_dpp v61, v34, v61 quad_perm:[2,2,2,2] row_mask:0xf bank_mask:0xf
s_nop 1
v_add_f32_dpp v61, v35, v61 quad_perm:[3,3,3,3] row_mask:0xf bank_mask:0xf
v_cvt_pk_bf16_f32 v61, v61, v61
v_and_b32 v61, 0xffff0000, v61
v_mul_f32 v61, s69, v61
v_cvt_pk_bf16_f32 v61, v61, v61
v_and_b32 v61, 0xffff0000, v61
v_max_f32 v7, v7, v61
ds_write_b32 v172, v61 offset:192
s_waitcnt vmcnt(6)
buffer_load_dwordx4 a[232:235], v4, s[40:43], s29 offen offset:2048 nt
v_mfma_f32_16x16x32_bf16 v[32:35], a[32:35], v[40:43], 0
v_mfma_f32_16x16x32_bf16 v[32:35], a[36:39], v[44:47], v[32:35]
s_nop 5
v_mov_b32_dpp v61, v36 quad_perm:[0,0,0,0] row_mask:0xf bank_mask:0xf
s_nop 1
v_add_f32_dpp v61, v37, v61 quad_perm:[1,1,1,1] row_mask:0xf bank_mask:0xf
s_nop 1
v_add_f32_dpp v61, v38, v61 quad_perm:[2,2,2,2] row_mask:0xf bank_mask:0xf
s_nop 1
v_add_f32_dpp v61, v39, v61 quad_perm:[3,3,3,3] row_mask:0xf bank_mask:0xf
v_cvt_pk_bf16_f32 v61, v61, v61
v_and_b32 v61, 0xffff0000, v61
v_mul_f32 v61, s69, v61
v_cvt_pk_bf16_f32 v61, v61, v61
v_and_b32 v61, 0xffff0000, v61
v_max_f32 v7, v7, v61
ds_write_b32 v172, v61 offset:256
v_mfma_f32_16x16x32_bf16 v[36:39], a[40:43], v[40:43], 0
v_mfma_f32_16x16x32_bf16 v[36:39], a[44:47], v[44:47], v[36:39]
s_nop 5
v_mov_b32_dpp v61, v32 quad_perm:[0,0,0,0] row_mask:0xf bank_mask:0xf
s_nop 1
v_add_f32_dpp v61, v33, v61 quad_perm:[1,1,1,1] row_mask:0xf bank_mask:0xf
s_nop 1
v_add_f32_dpp v61, v34, v61 quad_perm:[2,2,2,2] row_mask:0xf bank_mask:0xf
s_nop 1
v_add_f32_dpp v61, v35, v61 quad_perm:[3,3,3,3] row_mask:0xf bank_mask:0xf
v_cvt_pk_bf16_f32 v61, v61, v61
v_and_b32 v61, 0xffff0000, v61
v_mul_f32 v61, s69, v61
v_cvt_pk_bf16_f32 v61, v61, v61
v_and_b32 v61, 0xffff0000, v61
v_max_f32 v7, v7, v61
ds_write_b32 v172, v61 offset:320
s_waitcnt vmcnt(6)
buffer_load_dwordx4 a[236:239], v4, s[40:43], s29 offen offset:3072 nt
v_mfma_f32_16x16x32_bf16 v[32:35], a[48:51], v[40:43], 0
v_mfma_f32_16x16x32_bf16 v[32:35], a[52:55], v[44:47], v[32:35]
s_nop 5
v_mov_b32_dpp v61, v36 quad_perm:[0,0,0,0] row_mask:0xf bank_mask:0xf
s_nop 1
v_add_f32_dpp v61, v37, v61 quad_perm:[1,1,1,1] row_mask:0xf bank_mask:0xf
s_nop 1
v_add_f32_dpp v61, v38, v61 quad_perm:[2,2,2,2] row_mask:0xf bank_mask:0xf
s_nop 1
v_add_f32_dpp v61, v39, v61 quad_perm:[3,3,3,3] row_mask:0xf bank_mask:0xf
v_cvt_pk_bf16_f32 v61, v61, v61
v_and_b32 v61, 0xffff0000, v61
v_mul_f32 v61, s69, v61
v_cvt_pk_bf16_f32 v61, v61, v61
v_and_b32 v61, 0xffff0000, v61
v_max_f32 v7, v7, v61
ds_write_b32 v172, v61 offset:384
v_mfma_f32_16x16x32_bf16 v[36:39], a[56:59], v[40:43], 0
v_mfma_f32_16x16x32_bf16 v[36:39], a[60:63], v[44:47], v[36:39]
s_nop 5
v_mov_b32_dpp v61, v32 quad_perm:[0,0,0,0] row_mask:0xf bank_mask:0xf
s_nop 1
v_add_f32_dpp v61, v33, v61 quad_perm:[1,1,1,1] row_mask:0xf bank_mask:0xf
s_nop 1
v_add_f32_dpp v61, v34, v61 quad_perm:[2,2,2,2] row_mask:0xf bank_mask:0xf
s_nop 1
v_add_f32_dpp v61, v35, v61 quad_perm:[3,3,3,3] row_mask:0xf bank_mask:0xf
v_cvt_pk_bf16_f32 v61, v61, v61
v_and_b32 v61, 0xffff0000, v61
v_mul_f32 v61, s69, v61
v_cvt_pk_bf16_f32 v61, v61, v61
v_and_b32 v61, 0xffff0000, v61
v_max_f32 v7, v7, v61
ds_write_b32 v172, v61 offset:448
s_waitcnt vmcnt(6)
s_add_u32 s29, s27, 184320
buffer_load_dwordx4 a[240:243], v4, s[40:43], s29 offen offset:0 nt
v_mfma_f32_16x16x32_bf16 v[32:35], a[64:67], v[40:43], 0
v_mfma_f32_16x16x32_bf16 v[32:35], a[68:71], v[44:47], v[32:35]
s_nop 5
v_mov_b32_dpp v61, v36 quad_perm:[0,0,0,0] row_mask:0xf bank_mask:0xf
s_nop 1
v_add_f32_dpp v61, v37, v61 quad_perm:[1,1,1,1] row_mask:0xf bank_mask:0xf
s_nop 1
v_add_f32_dpp v61, v38, v61 quad_perm:[2,2,2,2] row_mask:0xf bank_mask:0xf
s_nop 1
v_add_f32_dpp v61, v39, v61 quad_perm:[3,3,3,3] row_mask:0xf bank_mask:0xf
v_cvt_pk_bf16_f32 v61, v61, v61
v_and_b32 v61, 0xffff0000, v61
v_mul_f32 v61, s69, v61
v_cvt_pk_bf16_f32 v61, v61, v61
v_and_b32 v61, 0xffff0000, v61
v_max_f32 v7, v7, v61
ds_write_b32 v172, v61 offset:512
v_mfma_f32_16x16x32_bf16 v[36:39], a[72:75], v[40:43], 0
v_mfma_f32_16x16x32_bf16 v[36:39], a[76:79], v[44:47], v[36:39]
s_nop 5
v_mov_b32_dpp v61, v32 quad_perm:[0,0,0,0] row_mask:0xf bank_mask:0xf
s_nop 1
v_add_f32_dpp v61, v33, v61 quad_perm:[1,1,1,1] row_mask:0xf bank_mask:0xf
s_nop 1
v_add_f32_dpp v61, v34, v61 quad_perm:[2,2,2,2] row_mask:0xf bank_mask:0xf
s_nop 1
v_add_f32_dpp v61, v35, v61 quad_perm:[3,3,3,3] row_mask:0xf bank_mask:0xf
v_cvt_pk_bf16_f32 v61, v61, v61
v_and_b32 v61, 0xffff0000, v61
v_mul_f32 v61, s69, v61
v_cvt_pk_bf16_f32 v61, v61, v61
v_and_b32 v61, 0xffff0000, v61
v_max_f32 v7, v7, v61
ds_write_b32 v172, v61 offset:576
s_waitcnt vmcnt(6)
buffer_load_dwordx4 a[244:247], v4, s[40:43], s29 offen offset:1024 nt
v_mfma_f32_16x16x32_bf16 v[32:35], a[80:83], v[40:43], 0
v_mfma_f32_16x16x32_bf16 v[32:35], a[84:87], v[44:47], v[32:35]
s_nop 5
v_mov_b32_dpp v61, v36 quad_perm:[0,0,0,0] row_mask:0xf bank_mask:0xf
s_nop 1
v_add_f32_dpp v61, v37, v61 quad_perm:[1,1,1,1] row_mask:0xf bank_mask:0xf
s_nop 1
v_add_f32_dpp v61, v38, v61 quad_perm:[2,2,2,2] row_mask:0xf bank_mask:0xf
s_nop 1
v_add_f32_dpp v61, v39, v61 quad_perm:[3,3,3,3] row_mask:0xf bank_mask:0xf
v_cvt_pk_bf16_f32 v61, v61, v61
v_and_b32 v61, 0xffff0000, v61
v_mul_f32 v61, s69, v61
v_cvt_pk_bf16_f32 v61, v61, v61
v_and_b32 v61, 0xffff0000, v61
v_max_f32 v7, v7, v61
ds_write_b32 v172, v61 offset:640
v_mfma_f32_16x16x32_bf16 v[36:39], a[88:91], v[40:43], 0
v_mfma_f32_16x16x32_bf16 v[36:39], a[92:95], v[44:47], v[36:39]
s_nop 5
v_mov_b32_dpp v61, v32 quad_perm:[0,0,0,0] row_mask:0xf bank_mask:0xf
s_nop 1
v_add_f32_dpp v61, v33, v61 quad_perm:[1,1,1,1] row_mask:0xf bank_mask:0xf
s_nop 1
v_add_f32_dpp v61, v34, v61 quad_perm:[2,2,2,2] row_mask:0xf bank_mask:0xf
s_nop 1
v_add_f32_dpp v61, v35, v61 quad_perm:[3,3,3,3] row_mask:0xf bank_mask:0xf
v_cvt_pk_bf16_f32 v61, v61, v61
v_and_b32 v61, 0xffff0000, v61
v_mul_f32 v61, s69, v61
v_cvt_pk_bf16_f32 v61, v61, v61
v_and_b32 v61, 0xffff0000, v61
v_max_f32 v7, v7, v61
ds_write_b32 v172, v61 offset:704
s_waitcnt vmcnt(6)
buffer_load_dwordx4 a[248:251], v4, s[40:43], s29 offen offset:2048 nt
v_mfma_f32_16x16x32_bf16 v[32:35], a[96:99], v[40:43], 0
v_mfma_f32_16x16x32_bf16 v[32:35], a[100:103], v[44:47], v[32:35]
s_nop 5
v_mov_b32_dpp v61, v36 quad_perm:[0,0,0,0] row_mask:0xf bank_mask:0xf
s_nop 1
v_add_f32_dpp v61, v37, v61 quad_perm:[1,1,1,1] row_mask:0xf bank_mask:0xf
s_nop 1
v_add_f32_dpp v61, v38, v61 quad_perm:[2,2,2,2] row_mask:0xf bank_mask:0xf
s_nop 1
v_add_f32_dpp v61, v39, v61 quad_perm:[3,3,3,3] row_mask:0xf bank_mask:0xf
v_cvt_pk_bf16_f32 v61, v61, v61
v_and_b32 v61, 0xffff0000, v61
v_mul_f32 v61, s69, v61
v_cvt_pk_bf16_f32 v61, v61, v61
v_and_b32 v61, 0xffff0000, v61
v_max_f32 v7, v7, v61
ds_write_b32 v172, v61 offset:768
v_mfma_f32_16x16x32_bf16 v[36:39], a[104:107], v[40:43], 0
v_mfma_f32_16x16x32_bf16 v[36:39], a[108:111], v[44:47], v[36:39]
s_nop 5
v_mov_b32_dpp v61, v32 quad_perm:[0,0,0,0] row_mask:0xf bank_mask:0xf
s_nop 1
v_add_f32_dpp v61, v33, v61 quad_perm:[1,1,1,1] row_mask:0xf bank_mask:0xf
s_nop 1
v_add_f32_dpp v61, v34, v61 quad_perm:[2,2,2,2] row_mask:0xf bank_mask:0xf
s_nop 1
v_add_f32_dpp v61, v35, v61 quad_perm:[3,3,3,3] row_mask:0xf bank_mask:0xf
v_cvt_pk_bf16_f32 v61, v61, v61
v_and_b32 v61, 0xffff0000, v61
v_mul_f32 v61, s69, v61
v_cvt_pk_bf16_f32 v61, v61, v61
v_and_b32 v61, 0xffff0000, v61
v_max_f32 v7, v7, v61
ds_write_b32 v172, v61 offset:832
s_waitcnt vmcnt(6)
buffer_load_dwordx4 a[252:255], v4, s[40:43], s29 offen offset:3072 nt
v_mfma_f32_16x16x32_bf16 v[32:35], a[112:115], v[40:43], 0
v_mfma_f32_16x16x32_bf16 v[32:35], a[116:119], v[44:47], v[32:35]
s_nop 5
v_mov_b32_dpp v61, v36 quad_perm:[0,0,0,0] row_mask:0xf bank_mask:0xf
s_nop 1
v_add_f32_dpp v61, v37, v61 quad_perm:[1,1,1,1] row_mask:0xf bank_mask:0xf
s_nop 1
v_add_f32_dpp v61, v38, v61 quad_perm:[2,2,2,2] row_mask:0xf bank_mask:0xf
s_nop 1
v_add_f32_dpp v61, v39, v61 quad_perm:[3,3,3,3] row_mask:0xf bank_mask:0xf
v_cvt_pk_bf16_f32 v61, v61, v61
v_and_b32 v61, 0xffff0000, v61
v_mul_f32 v61, s69, v61
v_cvt_pk_bf16_f32 v61, v61, v61
v_and_b32 v61, 0xffff0000, v61
v_max_f32 v7, v7, v61
ds_write_b32 v172, v61 offset:896
v_mfma_f32_16x16x32_bf16 v[36:39], a[120:123], v[40:43], 0
v_mfma_f32_16x16x32_bf16 v[36:39], a[124:127], v[44:47], v[36:39]
s_nop 5
v_mov_b32_dpp v61, v32 quad_perm:[0,0,0,0] row_mask:0xf bank_mask:0xf
s_nop 1
v_add_f32_dpp v61, v33, v61 quad_perm:[1,1,1,1] row_mask:0xf bank_mask:0xf
s_nop 1
v_add_f32_dpp v61, v34, v61 quad_perm:[2,2,2,2] row_mask:0xf bank_mask:0xf
s_nop 1
v_add_f32_dpp v61, v35, v61 quad_perm:[3,3,3,3] row_mask:0xf bank_mask:0xf
v_cvt_pk_bf16_f32 v61, v61, v61
v_and_b32 v61, 0xffff0000, v61
v_mul_f32 v61, s69, v61
v_cvt_pk_bf16_f32 v61, v61, v61
v_and_b32 v61, 0xffff0000, v61
v_max_f32 v7, v7, v61
ds_write_b32 v172, v61 offset:960
s_waitcnt vmcnt(6)
s_add_u32 s29, s27, 196608
buffer_load_dwordx4 v[64:67], v4, s[40:43], s29 offen offset:0 nt
v_mfma_f32_16x16x32_bf16 v[32:35], a[128:131], v[40:43], 0
v_mfma_f32_16x16x32_bf16 v[32:35], a[132:135], v[44:47], v[32:35]
s_nop 5
v_mov_b32_dpp v61, v36 quad_perm:[0,0,0,0] row_mask:0xf bank_mask:0xf
s_nop 1
v_add_f32_dpp v61, v37, v61 quad_perm:[1,1,1,1] row_mask:0xf bank_mask:0xf
s_nop 1
v_add_f32_dpp v61, v38, v61 quad_perm:[2,2,2,2] row_mask:0xf bank_mask:0xf
s_nop 1
v_add_f32_dpp v61, v39, v61 quad_perm:[3,3,3,3] row_mask:0xf bank_mask:0xf
v_cvt_pk_bf16_f32 v61, v61, v61
v_and_b32 v61, 0xffff0000, v61
v_mul_f32 v61, s69, v61
v_cvt_pk_bf16_f32 v61, v61, v61
v_and_b32 v61, 0xffff0000, v61
v_max_f32 v7, v7, v61
ds_write_b32 v172, v61 offset:1024
v_mfma_f32_16x16x32_bf16 v[36:39], a[136:139], v[40:43], 0
v_mfma_f32_16x16x32_bf16 v[36:39], a[140:143], v[44:47], v[36:39]
s_nop 5
v_mov_b32_dpp v61, v32 quad_perm:[0,0,0,0] row_mask:0xf bank_mask:0xf
s_nop 1
v_add_f32_dpp v61, v33, v61 quad_perm:[1,1,1,1] row_mask:0xf bank_mask:0xf
s_nop 1
v_add_f32_dpp v61, v34, v61 quad_perm:[2,2,2,2] row_mask:0xf bank_mask:0xf
s_nop 1
v_add_f32_dpp v61, v35, v61 quad_perm:[3,3,3,3] row_mask:0xf bank_mask:0xf
v_cvt_pk_bf16_f32 v61, v61, v61
v_and_b32 v61, 0xffff0000, v61
v_mul_f32 v61, s69, v61
v_cvt_pk_bf16_f32 v61, v61, v61
v_and_b32 v61, 0xffff0000, v61
v_max_f32 v7, v7, v61
ds_write_b32 v172, v61 offset:1088
s_waitcnt vmcnt(6)
buffer_load_dwordx4 v[68:71], v4, s[40:43], s29 offen offset:1024 nt
v_mfma_f32_16x16x32_bf16 v[32:35], a[144:147], v[40:43], 0
v_mfma_f32_16x16x32_bf16 v[32:35], a[148:151], v[44:47], v[32:35]
s_nop 5
v_mov_b32_dpp v61, v36 quad_perm:[0,0,0,0] row_mask:0xf bank_mask:0xf
s_nop 1
v_add_f32_dpp v61, v37, v61 quad_perm:[1,1,1,1] row_mask:0xf bank_mask:0xf
s_nop 1
v_add_f32_dpp v61, v38, v61 quad_perm:[2,2,2,2] row_mask:0xf bank_mask:0xf
s_nop 1
v_add_f32_dpp v61, v39, v61 quad_perm:[3,3,3,3] row_mask:0xf bank_mask:0xf
v_cvt_pk_bf16_f32 v61, v61, v61
v_and_b32 v61, 0xffff0000, v61
v_mul_f32 v61, s69, v61
v_cvt_pk_bf16_f32 v61, v61, v61
v_and_b32 v61, 0xffff0000, v61
v_max_f32 v7, v7, v61
ds_write_b32 v172, v61 offset:1152
v_mfma_f32_16x16x32_bf16 v[36:39], a[152:155], v[40:43], 0
v_mfma_f32_16x16x32_bf16 v[36:39], a[156:159], v[44:47], v[36:39]
s_nop 5
v_mov_b32_dpp v61, v32 quad_perm:[0,0,0,0] row_mask:0xf bank_mask:0xf
s_nop 1
v_add_f32_dpp v61, v33, v61 quad_perm:[1,1,1,1] row_mask:0xf bank_mask:0xf
s_nop 1
v_add_f32_dpp v61, v34, v61 quad_perm:[2,2,2,2] row_mask:0xf bank_mask:0xf
s_nop 1
v_add_f32_dpp v61, v35, v61 quad_perm:[3,3,3,3] row_mask:0xf bank_mask:0xf
v_cvt_pk_bf16_f32 v61, v61, v61
v_and_b32 v61, 0xffff0000, v61
v_mul_f32 v61, s69, v61
v_cvt_pk_bf16_f32 v61, v61, v61
v_and_b32 v61, 0xffff0000, v61
v_max_f32 v7, v7, v61
ds_write_b32 v172, v61 offset:1216
s_waitcnt vmcnt(6)
buffer_load_dwordx4 v[72:75], v4, s[40:43], s29 offen offset:2048 nt
v_mfma_f32_16x16x32_bf16 v[32:35], a[160:163], v[40:43], 0
v_mfma_f32_16x16x32_bf16 v[32:35], a[164:167], v[44:47], v[32:35]
s_nop 5
v_mov_b32_dpp v61, v36 quad_perm:[0,0,0,0] row_mask:0xf bank_mask:0xf
s_nop 1
v_add_f32_dpp v61, v37, v61 quad_perm:[1,1,1,1] row_mask:0xf bank_mask:0xf
s_nop 1
v_add_f32_dpp v61, v38, v61 quad_perm:[2,2,2,2] row_mask:0xf bank_mask:0xf
s_nop 1
v_add_f32_dpp v61, v39, v61 quad_perm:[3,3,3,3] row_mask:0xf bank_mask:0xf
v_cvt_pk_bf16_f32 v61, v61, v61
v_and_b32 v61, 0xffff0000, v61
v_mul_f32 v61, s69, v61
v_cvt_pk_bf16_f32 v61, v61, v61
v_and_b32 v61, 0xffff0000, v61
v_max_f32 v7, v7, v61
ds_write_b32 v172, v61 offset:1280
v_mfma_f32_16x16x32_bf16 v[36:39], a[168:171], v[40:43], 0
v_mfma_f32_16x16x32_bf16 v[36:39], a[172:175], v[44:47], v[36:39]
s_nop 5
v_mov_b32_dpp v61, v32 quad_perm:[0,0,0,0] row_mask:0xf bank_mask:0xf
s_nop 1
v_add_f32_dpp v61, v33, v61 quad_perm:[1,1,1,1] row_mask:0xf bank_mask:0xf
s_nop 1
v_add_f32_dpp v61, v34, v61 quad_perm:[2,2,2,2] row_mask:0xf bank_mask:0xf
s_nop 1
v_add_f32_dpp v61, v35, v61 quad_perm:[3,3,3,3] row_mask:0xf bank_mask:0xf
v_cvt_pk_bf16_f32 v61, v61, v61
v_and_b32 v61, 0xffff0000, v61
v_mul_f32 v61, s69, v61
v_cvt_pk_bf16_f32 v61, v61, v61
v_and_b32 v61, 0xffff0000, v61
v_max_f32 v7, v7, v61
ds_write_b32 v172, v61 offset:1344
s_waitcnt vmcnt(6)
buffer_load_dwordx4 v[76:79], v4, s[40:43], s29 offen offset:3072 nt
v_mfma_f32_16x16x32_bf16 v[32:35], a[176:179], v[40:43], 0
v_mfma_f32_16x16x32_bf16 v[32:35], a[180:183], v[44:47], v[32:35]
s_nop 5
v_mov_b32_dpp v61, v36 quad_perm:[0,0,0,0] row_mask:0xf bank_mask:0xf
s_nop 1
v_add_f32_dpp v61, v37, v61 quad_perm:[1,1,1,1] row_mask:0xf bank_mask:0xf
s_nop 1
v_add_f32_dpp v61, v38, v61 quad_perm:[2,2,2,2] row_mask:0xf bank_mask:0xf
s_nop 1
v_add_f32_dpp v61, v39, v61 quad_perm:[3,3,3,3] row_mask:0xf bank_mask:0xf
v_cvt_pk_bf16_f32 v61, v61, v61
v_and_b32 v61, 0xffff0000, v61
v_mul_f32 v61, s69, v61
v_cvt_pk_bf16_f32 v61, v61, v61
v_and_b32 v61, 0xffff0000, v61
v_max_f32 v7, v7, v61
ds_write_b32 v172, v61 offset:1408
v_mfma_f32_16x16x32_bf16 v[36:39], a[184:187], v[40:43], 0
v_mfma_f32_16x16x32_bf16 v[36:39], a[188:191], v[44:47], v[36:39]
s_nop 5
v_mov_b32_dpp v61, v32 quad_perm:[0,0,0,0] row_mask:0xf bank_mask:0xf
s_nop 1
v_add_f32_dpp v61, v33, v61 quad_perm:[1,1,1,1] row_mask:0xf bank_mask:0xf
s_nop 1
v_add_f32_dpp v61, v34, v61 quad_perm:[2,2,2,2] row_mask:0xf bank_mask:0xf
s_nop 1
v_add_f32_dpp v61, v35, v61 quad_perm:[3,3,3,3] row_mask:0xf bank_mask:0xf
v_cvt_pk_bf16_f32 v61, v61, v61
v_and_b32 v61, 0xffff0000, v61
v_mul_f32 v61, s69, v61
v_cvt_pk_bf16_f32 v61, v61, v61
v_and_b32 v61, 0xffff0000, v61
v_max_f32 v7, v7, v61
ds_write_b32 v172, v61 offset:1472
s_waitcnt vmcnt(6)
s_add_u32 s29, s27, 208896
buffer_load_dwordx4 v[80:83], v4, s[40:43], s29 offen offset:0 nt
v_mfma_f32_16x16x32_bf16 v[32:35], a[192:195], v[40:43], 0
v_mfma_f32_16x16x32_bf16 v[32:35], a[196:199], v[44:47], v[32:35]
s_nop 5
v_mov_b32_dpp v61, v36 quad_perm:[0,0,0,0] row_mask:0xf bank_mask:0xf
s_nop 1
v_add_f32_dpp v61, v37, v61 quad_perm:[1,1,1,1] row_mask:0xf bank_mask:0xf
s_nop 1
v_add_f32_dpp v61, v38, v61 quad_perm:[2,2,2,2] row_mask:0xf bank_mask:0xf
s_nop 1
v_add_f32_dpp v61, v39, v61 quad_perm:[3,3,3,3] row_mask:0xf bank_mask:0xf
v_cvt_pk_bf16_f32 v61, v61, v61
v_and_b32 v61, 0xffff0000, v61
v_mul_f32 v61, s69, v61
v_cvt_pk_bf16_f32 v61, v61, v61
v_and_b32 v61, 0xffff0000, v61
v_max_f32 v7, v7, v61
ds_write_b32 v172, v61 offset:1536
v_mfma_f32_16x16x32_bf16 v[36:39], a[200:203], v[40:43], 0
v_mfma_f32_16x16x32_bf16 v[36:39], a[204:207], v[44:47], v[36:39]
s_nop 5
v_mov_b32_dpp v61, v32 quad_perm:[0,0,0,0] row_mask:0xf bank_mask:0xf
s_nop 1
v_add_f32_dpp v61, v33, v61 quad_perm:[1,1,1,1] row_mask:0xf bank_mask:0xf
s_nop 1
v_add_f32_dpp v61, v34, v61 quad_perm:[2,2,2,2] row_mask:0xf bank_mask:0xf
s_nop 1
v_add_f32_dpp v61, v35, v61 quad_perm:[3,3,3,3] row_mask:0xf bank_mask:0xf
v_cvt_pk_bf16_f32 v61, v61, v61
v_and_b32 v61, 0xffff0000, v61
v_mul_f32 v61, s69, v61
v_cvt_pk_bf16_f32 v61, v61, v61
v_and_b32 v61, 0xffff0000, v61
v_max_f32 v7, v7, v61
ds_write_b32 v172, v61 offset:1600
s_waitcnt vmcnt(6)
buffer_load_dwordx4 v[84:87], v4, s[40:43], s29 offen offset:1024 nt
v_mfma_f32_16x16x32_bf16 v[32:35], a[208:211], v[40:43], 0
v_mfma_f32_16x16x32_bf16 v[32:35], a[212:215], v[44:47], v[32:35]
s_nop 5
v_mov_b32_dpp v61, v36 quad_perm:[0,0,0,0] row_mask:0xf bank_mask:0xf
s_nop 1
v_add_f32_dpp v61, v37, v61 quad_perm:[1,1,1,1] row_mask:0xf bank_mask:0xf
s_nop 1
v_add_f32_dpp v61, v38, v61 quad_perm:[2,2,2,2] row_mask:0xf bank_mask:0xf
s_nop 1
v_add_f32_dpp v61, v39, v61 quad_perm:[3,3,3,3] row_mask:0xf bank_mask:0xf
v_cvt_pk_bf16_f32 v61, v61, v61
v_and_b32 v61, 0xffff0000, v61
v_mul_f32 v61, s69, v61
v_cvt_pk_bf16_f32 v61, v61, v61
v_and_b32 v61, 0xffff0000, v61
v_max_f32 v7, v7, v61
ds_write_b32 v172, v61 offset:1664
v_mfma_f32_16x16x32_bf16 v[36:39], a[216:219], v[40:43], 0
v_mfma_f32_16x16x32_bf16 v[36:39], a[220:223], v[44:47], v[36:39]
s_nop 5
v_mov_b32_dpp v61, v32 quad_perm:[0,0,0,0] row_mask:0xf bank_mask:0xf
s_nop 1
v_add_f32_dpp v61, v33, v61 quad_perm:[1,1,1,1] row_mask:0xf bank_mask:0xf
s_nop 1
v_add_f32_dpp v61, v34, v61 quad_perm:[2,2,2,2] row_mask:0xf bank_mask:0xf
s_nop 1
v_add_f32_dpp v61, v35, v61 quad_perm:[3,3,3,3] row_mask:0xf bank_mask:0xf
v_cvt_pk_bf16_f32 v61, v61, v61
v_and_b32 v61, 0xffff0000, v61
v_mul_f32 v61, s69, v61
v_cvt_pk_bf16_f32 v61, v61, v61
v_and_b32 v61, 0xffff0000, v61
v_max_f32 v7, v7, v61
ds_write_b32 v172, v61 offset:1728
s_waitcnt vmcnt(6)
buffer_load_dwordx4 v[88:91], v4, s[40:43], s29 offen offset:2048 nt
v_mfma_f32_16x16x32_bf16 v[32:35], a[224:227], v[40:43], 0
v_mfma_f32_16x16x32_bf16 v[32:35], a[228:231], v[44:47], v[32:35]
s_nop 5
v_mov_b32_dpp v61, v36 quad_perm:[0,0,0,0] row_mask:0xf bank_mask:0xf
s_nop 1
v_add_f32_dpp v61, v37, v61 quad_perm:[1,1,1,1] row_mask:0xf bank_mask:0xf
s_nop 1
v_add_f32_dpp v61, v38, v61 quad_perm:[2,2,2,2] row_mask:0xf bank_mask:0xf
s_nop 1
v_add_f32_dpp v61, v39, v61 quad_perm:[3,3,3,3] row_mask:0xf bank_mask:0xf
v_cvt_pk_bf16_f32 v61, v61, v61
v_and_b32 v61, 0xffff0000, v61
v_mul_f32 v61, s69, v61
v_cvt_pk_bf16_f32 v61, v61, v61
v_and_b32 v61, 0xffff0000, v61
v_max_f32 v7, v7, v61
ds_write_b32 v172, v61 offset:1792
v_mfma_f32_16x16x32_bf16 v[36:39], a[232:235], v[40:43], 0
v_mfma_f32_16x16x32_bf16 v[36:39], a[236:239], v[44:47], v[36:39]
s_nop 5
v_mov_b32_dpp v61, v32 quad_perm:[0,0,0,0] row_mask:0xf bank_mask:0xf
s_nop 1
v_add_f32_dpp v61, v33, v61 quad_perm:[1,1,1,1] row_mask:0xf bank_mask:0xf
s_nop 1
v_add_f32_dpp v61, v34, v61 quad_perm:[2,2,2,2] row_mask:0xf bank_mask:0xf
s_nop 1
v_add_f32_dpp v61, v35, v61 quad_perm:[3,3,3,3] row_mask:0xf bank_mask:0xf
v_cvt_pk_bf16_f32 v61, v61, v61
v_and_b32 v61, 0xffff0000, v61
v_mul_f32 v61, s69, v61
v_cvt_pk_bf16_f32 v61, v61, v61
v_and_b32 v61, 0xffff0000, v61
v_max_f32 v7, v7, v61
ds_write_b32 v172, v61 offset:1856
v_mfma_f32_16x16x32_bf16 v[32:35], a[240:243], v[40:43], 0
v_mfma_f32_16x16x32_bf16 v[32:35], a[244:247], v[44:47], v[32:35]
s_nop 5
v_mov_b32_dpp v61, v36 quad_perm:[0,0,0,0] row_mask:0xf bank_mask:0xf
s_nop 1
v_add_f32_dpp v61, v37, v61 quad_perm:[1,1,1,1] row_mask:0xf bank_mask:0xf
s_nop 1
v_add_f32_dpp v61, v38, v61 quad_perm:[2,2,2,2] row_mask:0xf bank_mask:0xf
s_nop 1
v_add_f32_dpp v61, v39, v61 quad_perm:[3,3,3,3] row_mask:0xf bank_mask:0xf
v_cvt_pk_bf16_f32 v61, v61, v61
v_and_b32 v61, 0xffff0000, v61
v_mul_f32 v61, s69, v61
v_cvt_pk_bf16_f32 v61, v61, v61
v_and_b32 v61, 0xffff0000, v61
v_max_f32 v7, v7, v61
ds_write_b32 v172, v61 offset:1920
v_mfma_f32_16x16x32_bf16 v[36:39], a[248:251], v[40:43], 0
v_mfma_f32_16x16x32_bf16 v[36:39], a[252:255], v[44:47], v[36:39]
s_nop 5
v_mov_b32_dpp v61, v32 quad_perm:[0,0,0,0] row_mask:0xf bank_mask:0xf
s_nop 1
v_add_f32_dpp v61, v33, v61 quad_perm:[1,1,1,1] row_mask:0xf bank_mask:0xf
s_nop 1
v_add_f32_dpp v61, v34, v61 quad_perm:[2,2,2,2] row_mask:0xf bank_mask:0xf
s_nop 1
v_add_f32_dpp v61, v35, v61 quad_perm:[3,3,3,3] row_mask:0xf bank_mask:0xf
v_cvt_pk_bf16_f32 v61, v61, v61
v_and_b32 v61, 0xffff0000, v61
v_mul_f32 v61, s69, v61
v_cvt_pk_bf16_f32 v61, v61, v61
v_and_b32 v61, 0xffff0000, v61
v_max_f32 v7, v7, v61
ds_write_b32 v172, v61 offset:1984
s_add_u32 s27, s27, 196608
v_add_u32 v172, 2048, v172
s_mov_b32 s30, 16
L_kl1:
s_waitcnt vmcnt(6)
s_add_u32 s29, s27, 12288
buffer_load_dwordx4 v[92:95], v4, s[40:43], s29 offen offset:3072 nt
s_add_u32 s29, s27, 24576
buffer_load_dwordx4 v[96:99], v4, s[40:43], s29 offen offset:0 nt
v_mfma_f32_16x16x32_bf16 v[32:35], v[64:67], v[40:43], 0
s_waitcnt vmcnt(7)
buffer_load_dwordx4 v[100:103], v4, s[40:43], s29 offen offset:1024 nt
v_mfma_f32_16x16x32_bf16 v[32:35], v[68:71], v[44:47], v[32:35]
s_nop 5
v_mov_b32_dpp v61, v36 quad_perm:[0,0,0,0] row_mask:0xf bank_mask:0xf
s_nop 1
v_add_f32_dpp v61, v37, v61 quad_perm:[1,1,1,1] row_mask:0xf bank_mask:0xf
s_nop 1
v_add_f32_dpp v61, v38, v61 quad_perm:[2,2,2,2] row_mask:0xf bank_mask:0xf
s_nop 1
v_add_f32_dpp v61, v39, v61 quad_perm:[3,3,3,3] row_mask:0xf bank_mask:0xf
v_cvt_pk_bf16_f32 v61, v61, v61
v_and_b32 v61, 0xffff0000, v61
v_mul_f32 v61, s69, v61
v_cvt_pk_bf16_f32 v61, v61, v61
v_and_b32 v61, 0xffff0000, v61
v_max_f32 v7, v7, v61
ds_write_b32 v172, v61 offset:0
s_waitcnt vmcnt(7)
v_mfma_f32_16x16x32_bf16 v[36:39], v[72:75], v[40:43], 0
s_waitcnt vmcnt(6)
buffer_load_dwordx4 v[104:107], v4, s[40:43], s29 offen offset:2048 nt
v_mfma_f32_16x16x32_bf16 v[36:39], v[76:79], v[44:47], v[36:39]
s_nop 5
v_mov_b32_dpp v61, v32 quad_perm:[0,0,0,0] row_mask:0xf bank_mask:0xf
s_nop 1
v_add_f32_dpp v61, v33, v61 quad_perm:[1,1,1,1] row_mask:0xf bank_mask:0xf
s_nop 1
v_add_f32_dpp v61, v34, v61 quad_perm:[2,2,2,2] row_mask:0xf bank_mask:0xf
s_nop 1
v_add_f32_dpp v61, v35, v61 quad_perm:[3,3,3,3] row_mask:0xf bank_mask:0xf
v_cvt_pk_bf16_f32 v61, v61, v61
v_and_b32 v61, 0xffff0000, v61
v_mul_f32 v61, s69, v61
v_cvt_pk_bf16_f32 v61, v61, v61
v_and_b32 v61, 0xffff0000, v61
v_max_f32 v7, v7, v61
ds_write_b32 v172, v61 offset:64
s_waitcnt vmcnt(6)
buffer_load_dwordx4 v[108:111], v4, s[40:43], s29 offen offset:3072 nt
v_mfma_f32_16x16x32_bf16 v[32:35], v[80:83], v[40:43], 0
s_waitcnt vmcnt(6)
s_add_u32 s29, s27, 36864
buffer_load_dwordx4 v[112:115], v4, s[40:43], s29 offen offset:0 nt
v_mfma_f32_16x16x32_bf16 v[32:35], v[84:87], v[44:47], v[32:35]
s_nop 5
v_mov_b32_dpp v61, v36 quad_perm:[0,0,0,0] row_mask:0xf bank_mask:0xf
s_nop 1
v_add_f32_dpp v61, v37, v61 quad_perm:[1,1,1,1] row_mask:0xf bank_mask:0xf
s_nop 1
v_add_f32_dpp v61, v38, v61 quad_perm:[2,2,2,2] row_mask:0xf bank_mask:0xf
s_nop 1
v_add_f32_dpp v61, v39, v61 quad_perm:[3,3,3,3] row_mask:0xf bank_mask:0xf
v_cvt_pk_bf16_f32 v61, v61, v61
v_and_b32 v61, 0xffff0000, v61
v_mul_f32 v61, s69, v61
v_cvt_pk_bf16_f32 v61, v61, v61
v_and_b32 v61, 0xffff0000, v61
v_max_f32 v7, v7, v61
ds_write_b32 v172, v61 offset:128
s_waitcnt vmcnt(6)
buffer_load_dwordx4 v[116:119], v4, s[40:43], s29 offen offset:1024 nt
v_mfma_f32_16x16x32_bf16 v[36:39], v[88:91], v[40:43], 0
s_waitcnt vmcnt(6)
buffer_load_dwordx4 v[120:123], v4, s[40:43], s29 offen offset:2048 nt
v_mfma_f32_16x16x32_bf16 v[36:39], v[92:95], v[44:47], v[36:39]
s_nop 5
v_mov_b32_dpp v61, v32 quad_perm:[0,0,0,0] row_mask:0xf bank_mask:0xf
s_nop 1
v_add_f32_dpp v61, v33, v61 quad_perm:[1,1,1,1] row_mask:0xf bank_mask:0xf
s_nop 1
v_add_f32_dpp v61, v34, v61 quad_perm:[2,2,2,2] row_mask:0xf bank_mask:0xf
s_nop 1
v_add_f32_dpp v61, v35, v61 quad_perm:[3,3,3,3] row_mask:0xf bank_mask:0xf
v_cvt_pk_bf16_f32 v61, v61, v61
v_and_b32 v61, 0xffff0000, v61
v_mul_f32 v61, s69, v61
v_cvt_pk_bf16_f32 v61, v61, v61
v_and_b32 v61, 0xffff0000, v61
v_max_f32 v7, v7, v61
ds_write_b32 v172, v61 offset:192
s_waitcnt vmcnt(6)
buffer_load_dwordx4 v[124:127], v4, s[40:43], s29 offen offset:3072 nt
v_mfma_f32_16x16x32_bf16 v[32:35], v[96:99], v[40:43], 0
s_waitcnt vmcnt(6)
s_add_u32 s27, s27, 49152
s_cmp_lg_u32 s30, 1
s_cbranch_scc1 L_nl2
s_mov_b32 s27, s83
s_mov_b32 s96, s44
s_mov_b32 s97, s45
s_mov_b32 s98, s46
v_mov_b32 v173, v5
L_nl2:
buffer_load_dwordx4 v[64:67], v173, s[96:99], s27 offen offset:0 nt
v_mfma_f32_16x16x32_bf16 v[32:35], v[100:103], v[44:47], v[32:35]
s_nop 5
v_mov_b32_dpp v61, v36 quad_perm:[0,0,0,0] row_mask:0xf bank_mask:0xf
s_nop 1
v_add_f32_dpp v61, v37, v61 quad_perm:[1,1,1,1] row_mask:0xf bank_mask:0xf
s_nop 1
v_add_f32_dpp v61, v38, v61 quad_perm:[2,2,2,2] row_mask:0xf bank_mask:0xf
s_nop 1
v_add_f32_dpp v61, v39, v61 quad_perm:[3,3,3,3] row_mask:0xf bank_mask:0xf
v_cvt_pk_bf16_f32 v61, v61, v61
v_and_b32 v61, 0xffff0000, v61
v_mul_f32 v61, s69, v61
v_cvt_pk_bf16_f32 v61, v61, v61
v_and_b32 v61, 0xffff0000, v61
v_max_f32 v7, v7, v61
ds_write_b32 v172, v61 offset:256
s_waitcnt vmcnt(6)
buffer_load_dwordx4 v[68:71], v173, s[96:99], s27 offen offset:1024 nt
v_mfma_f32_16x16x32_bf16 v[36:39], v[104:107], v[40:43], 0
s_waitcnt vmcnt(6)
buffer_load_dwordx4 v[72:75], v173, s[96:99], s27 offen offset:2048 nt
v_mfma_f32_16x16x32_bf16 v[36:39], v[108:111], v[44:47], v[36:39]
s_nop 5
v_mov_b32_dpp v61, v32 quad_perm:[0,0,0,0] row_mask:0xf bank_mask:0xf
s_nop 1
v_add_f32_dpp v61, v33, v61 quad_perm:[1,1,1,1] row_mask:0xf bank_mask:0xf
s_nop 1
v_add_f32_dpp v61, v34, v61 quad_perm:[2,2,2,2] row_mask:0xf bank_mask:0xf
s_nop 1
v_add_f32_dpp v61, v35, v61 quad_perm:[3,3,3,3] row_mask:0xf bank_mask:0xf
v_cvt_pk_bf16_f32 v61, v61, v61
v_and_b32 v61, 0xffff0000, v61
v_mul_f32 v61, s69, v61
v_cvt_pk_bf16_f32 v61, v61, v61
v_and_b32 v61, 0xffff0000, v61
v_max_f32 v7, v7, v61
ds_write_b32 v172, v61 offset:320
s_waitcnt vmcnt(6)
buffer_load_dwordx4 v[76:79], v173, s[96:99], s27 offen offset:3072 nt
v_mfma_f32_16x16x32_bf16 v[32:35], v[112:115], v[40:43], 0
s_waitcnt vmcnt(6)
s_add_u32 s29, s27, s91
buffer_load_dwordx4 v[80:83], v173, s[96:99], s29 offen offset:0 nt
v_mfma_f32_16x16x32_bf16 v[32:35], v[116:119], v[44:47], v[32:35]
s_nop 5
v_mov_b32_dpp v61, v36 quad_perm:[0,0,0,0] row_mask:0xf bank_mask:0xf
s_nop 1
v_add_f32_dpp v61, v37, v61 quad_perm:[1,1,1,1] row_mask:0xf bank_mask:0xf
s_nop 1
v_add_f32_dpp v61, v38, v61 quad_perm:[2,2,2,2] row_mask:0xf bank_mask:0xf
s_nop 1
v_add_f32_dpp v61, v39, v61 quad_perm:[3,3,3,3] row_mask:0xf bank_mask:0xf
v_cvt_pk_bf16_f32 v61, v61, v61
v_and_b32 v61, 0xffff0000, v61
v_mul_f32 v61, s69, v61
v_cvt_pk_bf16_f32 v61, v61, v61
v_and_b32 v61, 0xffff0000, v61
v_max_f32 v7, v7, v61
ds_write_b32 v172, v61 offset:384
s_waitcnt vmcnt(6)
buffer_load_dwordx4 v[84:87], v173, s[96:99], s29 offen offset:1024 nt
v_mfma_f32_16x16x32_bf16 v[36:39], v[120:123], v[40:43], 0
s_waitcnt vmcnt(6)
buffer_load_dwordx4 v[88:91], v173, s[96:99], s29 offen offset:2048 nt
v_mfma_f32_16x16x32_bf16 v[36:39], v[124:127], v[44:47], v[36:39]
s_nop 5
v_mov_b32_dpp v61, v32 quad_perm:[0,0,0,0] row_mask:0xf bank_mask:0xf
s_nop 1
v_add_f32_dpp v61, v33, v61 quad_perm:[1,1,1,1] row_mask:0xf bank_mask:0xf
s_nop 1
v_add_f32_dpp v61, v34, v61 quad_perm:[2,2,2,2] row_mask:0xf bank_mask:0xf
s_nop 1
v_add_f32_dpp v61, v35, v61 quad_perm:[3,3,3,3] row_mask:0xf bank_mask:0xf
v_cvt_pk_bf16_f32 v61, v61, v61
v_and_b32 v61, 0xffff0000, v61
v_mul_f32 v61, s69, v61
v_cvt_pk_bf16_f32 v61, v61, v61
v_and_b32 v61, 0xffff0000, v61
v_max_f32 v7, v7, v61
ds_write_b32 v172, v61 offset:448
v_add_u32 v172, 512, v172
s_sub_u32 s30, s30, 1
s_cmp_lg_u32 s30, 0
s_cbranch_scc1 L_kl1
s_nop 7
v_mov_b32_dpp v61, v36 quad_perm:[0,0,0,0] row_mask:0xf bank_mask:0xf
s_nop 1
v_add_f32_dpp v61, v37, v61 quad_perm:[1,1,1,1] row_mask:0xf bank_mask:0xf
s_nop 1
v_add_f32_dpp v61, v38, v61 quad_perm:[2,2,2,2] row_mask:0xf bank_mask:0xf
s_nop 1
v_add_f32_dpp v61, v39, v61 quad_perm:[3,3,3,3] row_mask:0xf bank_mask:0xf
v_cvt_pk_bf16_f32 v61, v61, v61
v_and_b32 v61, 0xffff0000, v61
v_mul_f32 v61, s69, v61
v_cvt_pk_bf16_f32 v61, v61, v61
v_and_b32 v61, 0xffff0000, v61
v_max_f32 v7, v7, v61
ds_write_b32 v172, v61 offset:0
v_mov_b32 v60, 0xff800000
ds_write_b32 v172, v60 offset:64
ds_write_b32 v172, v60 offset:128
v_mov_b32 v172, v174
s_waitcnt lgkmcnt(0)
ds_read_b32 v140, v172 offset:64
ds_read_b32 v141, v172 offset:128
s_nop 1
v_max_f32_dpp v7, v7, v7 row_half_mirror row_mask:0xf bank_mask:0xf
v_mov_b32 v14, v7
s_nop 1
v_permlane16_swap_b32 v7, v14
v_max_f32 v7, v7, v14
v_mov_b32 v14, v7
s_nop 1
v_permlane32_swap_b32 v7, v14
v_max_f32 v7, v7, v14
v_mov_b32 v53, v7
v_mul_f32 v54, s68, v7
s_mov_b32 s30, 20
s_waitcnt lgkmcnt(0)
v_fma_f32 v60, v140, s68, -v54
v_exp_f32 v60, v60
s_nop 0
v_add_f32 v52, v52, v60
v_cvt_pk_bf16_f32 v136, v60, v60
L_vl3:
s_waitcnt vmcnt(6)
s_add_u32 s29, s27, 12288
buffer_load_dwordx4 v[92:95], v5, s[44:47], s29 offen offset:3072 nt
s_add_u32 s29, s27, 24576
buffer_load_dwordx4 v[96:99], v5, s[44:47], s29 offen offset:0 nt
ds_read_b32 v142, v172 offset:192
s_waitcnt lgkmcnt(1)
v_fma_f32 v60, v141, s68, -v54
v_exp_f32 v60, v60
s_nop 0
v_add_f32 v52, v52, v60
v_cvt_pk_bf16_f32 v137, v60, v60
v_and_b32 v128, v136, v8
v_and_b32 v129, v136, v9
v_and_b32_dpp v130, v136, v10 row_half_mirror row_mask:0xf bank_mask:0xf
v_and_b32_dpp v131, v136, v11 row_half_mirror row_mask:0xf bank_mask:0xf
s_nop 1
v_mfma_f32_16x16x32_bf16 v[48:51], v[64:67], v[128:131], v[48:51]
s_waitcnt vmcnt(7)
buffer_load_dwordx4 v[100:103], v5, s[44:47], s29 offen offset:1024 nt
v_and_b32_dpp v132, v136, v8 row_half_mirror row_mask:0xf bank_mask:0xf
v_and_b32_dpp v133, v136, v9 row_half_mirror row_mask:0xf bank_mask:0xf
v_and_b32 v134, v136, v10
v_and_b32 v135, v136, v11
s_nop 1
v_mfma_f32_16x16x32_bf16 v[48:51], v[68:71], v[132:135], v[48:51]
s_waitcnt vmcnt(7)
ds_read_b32 v143, v172 offset:256
s_waitcnt lgkmcnt(1)
v_fma_f32 v60, v142, s68, -v54
v_exp_f32 v60, v60
s_nop 0
v_add_f32 v52, v52, v60
v_cvt_pk_bf16_f32 v136, v60, v60
v_and_b32 v128, v137, v8
v_and_b32 v129, v137, v9
v_and_b32_dpp v130, v137, v10 row_half_mirror row_mask:0xf bank_mask:0xf
v_and_b32_dpp v131, v137, v11 row_half_mirror row_mask:0xf bank_mask:0xf
s_nop 1
v_mfma_f32_16x16x32_bf16 v[48:51], v[72:75], v[128:131], v[48:51]
s_waitcnt vmcnt(6)
buffer_load_dwordx4 v[104:107], v5, s[44:47], s29 offen offset:2048 nt
v_and_b32_dpp v132, v137, v8 row_half_mirror row_mask:0xf bank_mask:0xf
v_and_b32_dpp v133, v137, v9 row_half_mirror row_mask:0xf bank_mask:0xf
v_and_b32 v134, v137, v10
v_and_b32 v135, v137, v11
s_nop 1
v_mfma_f32_16x16x32_bf16 v[48:51], v[76:79], v[132:135], v[48:51]
s_waitcnt vmcnt(6)
buffer_load_dwordx4 v[108:111], v5, s[44:47], s29 offen offset:3072 nt
ds_read_b32 v140, v172 offset:320
s_waitcnt lgkmcnt(1)
v_fma_f32 v60, v143, s68, -v54
v_exp_f32 v60, v60
s_nop 0
v_add_f32 v52, v52, v60
v_cvt_pk_bf16_f32 v137, v60, v60
v_and_b32 v128, v136, v8
v_and_b32 v129, v136, v9
v_and_b32_dpp v130, v136, v10 row_half_mirror row_mask:0xf bank_mask:0xf
v_and_b32_dpp v131, v136, v11 row_half_mirror row_mask:0xf bank_mask:0xf
s_nop 1
v_mfma_f32_16x16x32_bf16 v[48:51], v[80:83], v[128:131], v[48:51]
s_waitcnt vmcnt(6)
s_add_u32 s29, s27, 36864
buffer_load_dwordx4 v[112:115], v5, s[44:47], s29 offen offset:0 nt
v_and_b32_dpp v132, v136, v8 row_half_mirror row_mask:0xf bank_mask:0xf
v_and_b32_dpp v133, v136, v9 row_half_mirror row_mask:0xf bank_mask:0xf
v_and_b32 v134, v136, v10
v_and_b32 v135, v136, v11
s_nop 1
v_mfma_f32_16x16x32_bf16 v[48:51], v[84:87], v[132:135], v[48:51]
s_waitcnt vmcnt(6)
buffer_load_dwordx4 v[116:119], v5, s[44:47], s29 offen offset:1024 nt
ds_read_b32 v141, v172 offset:384
s_waitcnt lgkmcnt(1)
v_fma_f32 v60, v140, s68, -v54
v_exp_f32 v60, v60
s_nop 0
v_add_f32 v52, v52, v60
v_cvt_pk_bf16_f32 v136, v60, v60
v_and_b32 v128, v137, v8
v_and_b32 v129, v137, v9
v_and_b32_dpp v130, v137, v10 row_half_mirror row_mask:0xf bank_mask:0xf
v_and_b32_dpp v131, v137, v11 row_half_mirror row_mask:0xf bank_mask:0xf
s_nop 1
v_mfma_f32_16x16x32_bf16 v[48:51], v[88:91], v[128:131], v[48:51]
s_waitcnt vmcnt(6)
buffer_load_dwordx4 v[120:123], v5, s[44:47], s29 offen offset:2048 nt
v_and_b32_dpp v132, v137, v8 row_half_mirror row_mask:0xf bank_mask:0xf
v_and_b32_dpp v133, v137, v9 row_half_mirror row_mask:0xf bank_mask:0xf
v_and_b32 v134, v137, v10
v_and_b32 v135, v137, v11
s_nop 1
v_mfma_f32_16x16x32_bf16 v[48:51], v[92:95], v[132:135], v[48:51]
s_waitcnt vmcnt(6)
buffer_load_dwordx4 v[124:127], v5, s[44:47], s29 offen offset:3072 nt
ds_read_b32 v142, v172 offset:448
s_waitcnt lgkmcnt(1)
v_fma_f32 v60, v141, s68, -v54
v_exp_f32 v60, v60
s_nop 0
v_add_f32 v52, v52, v60
v_cvt_pk_bf16_f32 v137, v60, v60
v_and_b32 v128, v136, v8
v_and_b32 v129, v136, v9
v_and_b32_dpp v130, v136, v10 row_half_mirror row_mask:0xf bank_mask:0xf
v_and_b32_dpp v131, v136, v11 row_half_mirror row_mask:0xf bank_mask:0xf
s_nop 1
v_mfma_f32_16x16x32_bf16 v[48:51], v[96:99], v[128:131], v[48:51]
s_waitcnt vmcnt(6)
s_add_u32 s27, s27, 49152
s_cmp_lg_u32 s30, 1
s_cbranch_scc1 L_nl4
s_mov_b32 s27, s92
s_mov_b32 s96, s4
s_mov_b32 s97, s5
s_mov_b32 s98, s6
v_mov_b32 v173, v4
L_nl4:
buffer_load_dwordx4 v[64:67], v173, s[96:99], s27 offen offset:0 nt
v_and_b32_dpp v132, v136, v8 row_half_mirror row_mask:0xf bank_mask:0xf
v_and_b32_dpp v133, v136, v9 row_half_mirror row_mask:0xf bank_mask:0xf
v_and_b32 v134, v136, v10
v_and_b32 v135, v136, v11
s_nop 1
v_mfma_f32_16x16x32_bf16 v[48:51], v[100:103], v[132:135], v[48:51]
s_waitcnt vmcnt(6)
buffer_load_dwordx4 v[68:71], v173, s[96:99], s27 offen offset:1024 nt
ds_read_b32 v143, v172 offset:512
s_waitcnt lgkmcnt(1)
v_fma_f32 v60, v142, s68, -v54
v_exp_f32 v60, v60
s_nop 0
v_add_f32 v52, v52, v60
v_cvt_pk_bf16_f32 v136, v60, v60
v_and_b32 v128, v137, v8
v_and_b32 v129, v137, v9
v_and_b32_dpp v130, v137, v10 row_half_mirror row_mask:0xf bank_mask:0xf
v_and_b32_dpp v131, v137, v11 row_half_mirror row_mask:0xf bank_mask:0xf
s_nop 1
v_mfma_f32_16x16x32_bf16 v[48:51], v[104:107], v[128:131], v[48:51]
s_waitcnt vmcnt(6)
buffer_load_dwordx4 v[72:75], v173, s[96:99], s27 offen offset:2048 nt
v_and_b32_dpp v132, v137, v8 row_half_mirror row_mask:0xf bank_mask:0xf
v_and_b32_dpp v133, v137, v9 row_half_mirror row_mask:0xf bank_mask:0xf
v_and_b32 v134, v137, v10
v_and_b32 v135, v137, v11
s_nop 1
v_mfma_f32_16x16x32_bf16 v[48:51], v[108:111], v[132:135], v[48:51]
s_waitcnt vmcnt(6)
buffer_load_dwordx4 v[76:79], v173, s[96:99], s27 offen offset:3072 nt
ds_read_b32 v140, v172 offset:576
s_waitcnt lgkmcnt(1)
v_fma_f32 v60, v143, s68, -v54
v_exp_f32 v60, v60
s_nop 0
v_add_f32 v52, v52, v60
v_cvt_pk_bf16_f32 v137, v60, v60
v_and_b32 v128, v136, v8
v_and_b32 v129, v136, v9
v_and_b32_dpp v130, v136, v10 row_half_mirror row_mask:0xf bank_mask:0xf
v_and_b32_dpp v131, v136, v11 row_half_mirror row_mask:0xf bank_mask:0xf
s_nop 1
v_mfma_f32_16x16x32_bf16 v[48:51], v[112:115], v[128:131], v[48:51]
s_waitcnt vmcnt(6)
s_add_u32 s29, s27, s91
buffer_load_dwordx4 v[80:83], v173, s[96:99], s29 offen offset:0 nt
v_and_b32_dpp v132, v136, v8 row_half_mirror row_mask:0xf bank_mask:0xf
v_and_b32_dpp v133, v136, v9 row_half_mirror row_mask:0xf bank_mask:0xf
v_and_b32 v134, v136, v10
v_and_b32 v135, v136, v11
s_nop 1
v_mfma_f32_16x16x32_bf16 v[48:51], v[116:119], v[132:135], v[48:51]
s_waitcnt vmcnt(6)
buffer_load_dwordx4 v[84:87], v173, s[96:99], s29 offen offset:1024 nt
ds_read_b32 v141, v172 offset:640
s_waitcnt lgkmcnt(1)
v_fma_f32 v60, v140, s68, -v54
v_exp_f32 v60, v60
s_nop 0
v_add_f32 v52, v52, v60
v_cvt_pk_bf16_f32 v136, v60, v60
v_and_b32 v128, v137, v8
v_and_b32 v129, v137, v9
v_and_b32_dpp v130, v137, v10 row_half_mirror row_mask:0xf bank_mask:0xf
v_and_b32_dpp v131, v137, v11 row_half_mirror row_mask:0xf bank_mask:0xf
s_nop 1
v_mfma_f32_16x16x32_bf16 v[48:51], v[120:123], v[128:131], v[48:51]
s_waitcnt vmcnt(6)
buffer_load_dwordx4 v[88:91], v173, s[96:99], s29 offen offset:2048 nt
v_and_b32_dpp v132, v137, v8 row_half_mirror row_mask:0xf bank_mask:0xf
v_and_b32_dpp v133, v137, v9 row_half_mirror row_mask:0xf bank_mask:0xf
v_and_b32 v134, v137, v10
v_and_b32 v135, v137, v11
s_nop 1
v_mfma_f32_16x16x32_bf16 v[48:51], v[124:127], v[132:135], v[48:51]
v_add_u32 v172, 512, v172
s_sub_u32 s30, s30, 1
s_cmp_lg_u32 s30, 0
s_cbranch_scc1 L_vl3
s_waitcnt lgkmcnt(0)
v_mov_b32 v172, v174
v_mov_b32 v7, 0xff800000
v_mov_b32 v36, 0xff800000
v_mov_b32 v37, 0xff800000
v_mov_b32 v38, 0xff800000
v_mov_b32 v39, 0xff800000
s_mov_b32 s30, 40
L_kl5:
s_waitcnt vmcnt(6)
s_add_u32 s29, s27, 12288
buffer_load_dwordx4 v[92:95], v4, s[4:7], s29 offen offset:3072 nt
s_add_u32 s29, s27, 24576
buffer_load_dwordx4 v[96:99], v4, s[4:7], s29 offen offset:0 nt
v_mfma_f32_16x16x32_bf16 v[32:35], v[64:67], v[16:19], 0
s_waitcnt vmcnt(7)
buffer_load_dwordx4 v[100:103], v4, s[4:7], s29 offen offset:1024 nt
v_mfma_f32_16x16x32_bf16 v[32:35], v[68:71], v[20:23], v[32:35]
s_waitcnt vmcnt(7)
v_mfma_f32_16x16x32_bf16 v[32:35], v[72:75], v[24:27], v[32:35]
s_waitcnt vmcnt(6)
buffer_load_dwordx4 v[104:107], v4, s[4:7], s29 offen offset:2048 nt
v_mfma_f32_16x16x32_bf16 v[32:35], v[76:79], v[28:31], v[32:35]
v_mov_b32_dpp v61, v36 quad_perm:[0,0,0,0] row_mask:0xf bank_mask:0xf
s_nop 1
v_add_f32_dpp v61, v37, v61 quad_perm:[1,1,1,1] row_mask:0xf bank_mask:0xf
s_nop 1
v_add_f32_dpp v61, v38, v61 quad_perm:[2,2,2,2] row_mask:0xf bank_mask:0xf
s_nop 1
v_add_f32_dpp v61, v39, v61 quad_perm:[3,3,3,3] row_mask:0xf bank_mask:0xf
v_cvt_pk_bf16_f32 v61, v61, v61
v_and_b32 v61, 0xffff0000, v61
v_mul_f32 v61, s69, v61
v_cvt_pk_bf16_f32 v61, v61, v61
v_and_b32 v61, 0xffff0000, v61
v_max_f32 v7, v7, v61
ds_write_b32 v172, v61 offset:0
s_waitcnt vmcnt(6)
buffer_load_dwordx4 v[108:111], v4, s[4:7], s29 offen offset:3072 nt
v_mfma_f32_16x16x32_bf16 v[36:39], v[80:83], v[16:19], 0
s_waitcnt vmcnt(6)
s_add_u32 s29, s27, 36864
buffer_load_dwordx4 v[112:115], v4, s[4:7], s29 offen offset:0 nt
v_mfma_f32_16x16x32_bf16 v[36:39], v[84:87], v[20:23], v[36:39]
s_waitcnt vmcnt(6)
buffer_load_dwordx4 v[116:119], v4, s[4:7], s29 offen offset:1024 nt
v_mfma_f32_16x16x32_bf16 v[36:39], v[88:91], v[24:27], v[36:39]
s_waitcnt vmcnt(6)
buffer_load_dwordx4 v[120:123], v4, s[4:7], s29 offen offset:2048 nt
v_mfma_f32_16x16x32_bf16 v[36:39], v[92:95], v[28:31], v[36:39]
v_mov_b32_dpp v61, v32 quad_perm:[0,0,0,0] row_mask:0xf bank_mask:0xf
s_nop 1
v_add_f32_dpp v61, v33, v61 quad_perm:[1,1,1,1] row_mask:0xf bank_mask:0xf
s_nop 1
v_add_f32_dpp v61, v34, v61 quad_perm:[2,2,2,2] row_mask:0xf bank_mask:0xf
s_nop 1
v_add_f32_dpp v61, v35, v61 quad_perm:[3,3,3,3] row_mask:0xf bank_mask:0xf
v_cvt_pk_bf16_f32 v61, v61, v61
v_and_b32 v61, 0xffff0000, v61
v_mul_f32 v61, s69, v61
v_cvt_pk_bf16_f32 v61, v61, v61
v_and_b32 v61, 0xffff0000, v61
v_max_f32 v7, v7, v61
ds_write_b32 v172, v61 offset:64
s_waitcnt vmcnt(6)
buffer_load_dwordx4 v[124:127], v4, s[4:7], s29 offen offset:3072 nt
v_mfma_f32_16x16x32_bf16 v[32:35], v[96:99], v[16:19], 0
s_waitcnt vmcnt(6)
s_add_u32 s27, s27, 49152
s_cmp_lg_u32 s30, 1
s_cbranch_scc1 L_nl6
s_mov_b32 s27, s92
s_mov_b32 s96, s8
s_mov_b32 s97, s9
s_mov_b32 s98, s10
v_mov_b32 v173, v5
L_nl6:
buffer_load_dwordx4 v[64:67], v173, s[96:99], s27 offen offset:0 nt
v_mfma_f32_16x16x32_bf16 v[32:35], v[100:103], v[20:23], v[32:35]
s_waitcnt vmcnt(6)
buffer_load_dwordx4 v[68:71], v173, s[96:99], s27 offen offset:1024 nt
v_mfma_f32_16x16x32_bf16 v[32:35], v[104:107], v[24:27], v[32:35]
s_waitcnt vmcnt(6)
buffer_load_dwordx4 v[72:75], v173, s[96:99], s27 offen offset:2048 nt
v_mfma_f32_16x16x32_bf16 v[32:35], v[108:111], v[28:31], v[32:35]
v_mov_b32_dpp v61, v36 quad_perm:[0,0,0,0] row_mask:0xf bank_mask:0xf
s_nop 1
v_add_f32_dpp v61, v37, v61 quad_perm:[1,1,1,1] row_mask:0xf bank_mask:0xf
s_nop 1
v_add_f32_dpp v61, v38, v61 quad_perm:[2,2,2,2] row_mask:0xf bank_mask:0xf
s_nop 1
v_add_f32_dpp v61, v39, v61 quad_perm:[3,3,3,3] row_mask:0xf bank_mask:0xf
v_cvt_pk_bf16_f32 v61, v61, v61
v_and_b32 v61, 0xffff0000, v61
v_mul_f32 v61, s69, v61
v_cvt_pk_bf16_f32 v61, v61, v61
v_and_b32 v61, 0xffff0000, v61
v_max_f32 v7, v7, v61
ds_write_b32 v172, v61 offset:128
s_waitcnt vmcnt(6)
buffer_load_dwordx4 v[76:79], v173, s[96:99], s27 offen offset:3072 nt
v_mfma_f32_16x16x32_bf16 v[36:39], v[112:115], v[16:19], 0
s_waitcnt vmcnt(6)
s_add_u32 s29, s27, s91
buffer_load_dwordx4 v[80:83], v173, s[96:99], s29 offen offset:0 nt
v_mfma_f32_16x16x32_bf16 v[36:39], v[116:119], v[20:23], v[36:39]
s_waitcnt vmcnt(6)
buffer_load_dwordx4 v[84:87], v173, s[96:99], s29 offen offset:1024 nt
v_mfma_f32_16x16x32_bf16 v[36:39], v[120:123], v[24:27], v[36:39]
s_waitcnt vmcnt(6)
buffer_load_dwordx4 v[88:91], v173, s[96:99], s29 offen offset:2048 nt
v_mfma_f32_16x16x32_bf16 v[36:39], v[124:127], v[28:31], v[36:39]
v_mov_b32_dpp v61, v32 quad_perm:[0,0,0,0] row_mask:0xf bank_mask:0xf
s_nop 1
v_add_f32_dpp v61, v33, v61 quad_perm:[1,1,1,1] row_mask:0xf bank_mask:0xf
s_nop 1
v_add_f32_dpp v61, v34, v61 quad_perm:[2,2,2,2] row_mask:0xf bank_mask:0xf
s_nop 1
v_add_f32_dpp v61, v35, v61 quad_perm:[3,3,3,3] row_mask:0xf bank_mask:0xf
v_cvt_pk_bf16_f32 v61, v61, v61
v_and_b32 v61, 0xffff0000, v61
v_mul_f32 v61, s69, v61
v_cvt_pk_bf16_f32 v61, v61, v61
v_and_b32 v61, 0xffff0000, v61
v_max_f32 v7, v7, v61
ds_write_b32 v172, v61 offset:192
v_add_u32 v172, 256, v172
s_sub_u32 s30, s30, 1
s_cmp_lg_u32 s30, 0
s_cbranch_scc1 L_kl5
s_nop 7
v_mov_b32_dpp v61, v36 quad_perm:[0,0,0,0] row_mask:0xf bank_mask:0xf
s_nop 1
v_add_f32_dpp v61, v37, v61 quad_perm:[1,1,1,1] row_mask:0xf bank_mask:0xf
s_nop 1
v_add_f32_dpp v61, v38, v61 quad_perm:[2,2,2,2] row_mask:0xf bank_mask:0xf
s_nop 1
v_add_f32_dpp v61, v39, v61 quad_perm:[3,3,3,3] row_mask:0xf bank_mask:0xf
v_cvt_pk_bf16_f32 v61, v61, v61
v_and_b32 v61, 0xffff0000, v61
v_mul_f32 v61, s69, v61
v_cvt_pk_bf16_f32 v61, v61, v61
v_and_b32 v61, 0xffff0000, v61
v_max_f32 v7, v7, v61
ds_write_b32 v172, v61 offset:0
v_mov_b32 v60, 0xff800000
ds_write_b32 v172, v60 offset:64
ds_write_b32 v172, v60 offset:128
v_mov_b32 v172, v174
s_waitcnt lgkmcnt(0)
ds_read_b32 v140, v172 offset:64
ds_read_b32 v141, v172 offset:128
s_nop 1
v_max_f32_dpp v7, v7, v7 row_half_mirror row_mask:0xf bank_mask:0xf
s_nop 1
v_max_f32_dpp v7, v7, v7 row_ror:8 row_mask:0xf bank_mask:0xf
v_mov_b32 v14, v7
s_nop 1
v_permlane16_swap_b32 v7, v14
v_max_f32 v7, v7, v14
v_mov_b32 v14, v7
s_nop 1
v_permlane32_swap_b32 v7, v14
v_max_f32 v7, v7, v14
v_mov_b32 v12, v7
v_mul_f32 v13, s68, v7
s_mov_b32 s30, 40
s_waitcnt lgkmcnt(0)
v_fma_f32 v60, v140, s68, -v13
v_exp_f32 v60, v60
s_nop 0
v_add_f32 v6, v6, v60
v_cvt_pk_bf16_f32 v136, v60, v60
L_vl7:
s_waitcnt vmcnt(6)
s_add_u32 s29, s27, 12288
buffer_load_dwordx4 v[92:95], v5, s[8:11], s29 offen offset:3072 nt
s_add_u32 s29, s27, 24576
buffer_load_dwordx4 v[96:99], v5, s[8:11], s29 offen offset:0 nt
ds_read_b32 v142, v172 offset:192
s_waitcnt lgkmcnt(1)
v_fma_f32 v60, v141, s68, -v13
v_exp_f32 v60, v60
s_nop 0
v_add_f32 v6, v6, v60
v_cvt_pk_bf16_f32 v137, v60, v60
v_and_b32_dpp v128, v136, v8 row_newbcast:0 row_mask:0xf bank_mask:0xf
v_and_b32_dpp v129, v136, v9 row_newbcast:0 row_mask:0xf bank_mask:0xf
v_and_b32_dpp v130, v136, v10 row_newbcast:0 row_mask:0xf bank_mask:0xf
v_and_b32_dpp v131, v136, v11 row_newbcast:0 row_mask:0xf bank_mask:0xf
s_nop 1
v_mfma_f32_16x16x32_bf16 v[56:59], v[64:67], v[128:131], v[56:59]
s_waitcnt vmcnt(7)
buffer_load_dwordx4 v[100:103], v5, s[8:11], s29 offen offset:1024 nt
v_and_b32_dpp v132, v136, v8 row_newbcast:4 row_mask:0xf bank_mask:0xf
v_and_b32_dpp v133, v136, v9 row_newbcast:4 row_mask:0xf bank_mask:0xf
v_and_b32_dpp v134, v136, v10 row_newbcast:4 row_mask:0xf bank_mask:0xf
v_and_b32_dpp v135, v136, v11 row_newbcast:4 row_mask:0xf bank_mask:0xf
s_nop 1
v_mfma_f32_16x16x32_bf16 v[56:59], v[68:71], v[132:135], v[56:59]
s_waitcnt vmcnt(7)
v_and_b32_dpp v128, v136, v8 row_newbcast:8 row_mask:0xf bank_mask:0xf
v_and_b32_dpp v129, v136, v9 row_newbcast:8 row_mask:0xf bank_mask:0xf
v_and_b32_dpp v130, v136, v10 row_newbcast:8 row_mask:0xf bank_mask:0xf
v_and_b32_dpp v131, v136, v11 row_newbcast:8 row_mask:0xf bank_mask:0xf
s_nop 1
v_mfma_f32_16x16x32_bf16 v[56:59], v[72:75], v[128:131], v[56:59]
s_waitcnt vmcnt(6)
buffer_load_dwordx4 v[104:107], v5, s[8:11], s29 offen offset:2048 nt
v_and_b32_dpp v132, v136, v8 row_newbcast:12 row_mask:0xf bank_mask:0xf
v_and_b32_dpp v133, v136, v9 row_newbcast:12 row_mask:0xf bank_mask:0xf
v_and_b32_dpp v134, v136, v10 row_newbcast:12 row_mask:0xf bank_mask:0xf
v_and_b32_dpp v135, v136, v11 row_newbcast:12 row_mask:0xf bank_mask:0xf
s_nop 1
v_mfma_f32_16x16x32_bf16 v[56:59], v[76:79], v[132:135], v[56:59]
s_waitcnt vmcnt(6)
buffer_load_dwordx4 v[108:111], v5, s[8:11], s29 offen offset:3072 nt
ds_read_b32 v143, v172 offset:256
s_waitcnt lgkmcnt(1)
v_fma_f32 v60, v142, s68, -v13
v_exp_f32 v60, v60
s_nop 0
v_add_f32 v6, v6, v60
v_cvt_pk_bf16_f32 v136, v60, v60
v_and_b32_dpp v128, v137, v8 row_newbcast:0 row_mask:0xf bank_mask:0xf
v_and_b32_dpp v129, v137, v9 row_newbcast:0 row_mask:0xf bank_mask:0xf
v_and_b32_dpp v130, v137, v10 row_newbcast:0 row_mask:0xf bank_mask:0xf
v_and_b32_dpp v131, v137, v11 row_newbcast:0 row_mask:0xf bank_mask:0xf
s_nop 1
v_mfma_f32_16x16x32_bf16 v[56:59], v[80:83], v[128:131], v[56:59]
s_waitcnt vmcnt(6)
s_add_u32 s29, s27, 36864
buffer_load_dwordx4 v[112:115], v5, s[8:11], s29 offen offset:0 nt
v_and_b32_dpp v132, v137, v8 row_newbcast:4 row_mask:0xf bank_mask:0xf
v_and_b32_dpp v133, v137, v9 row_newbcast:4 row_mask:0xf bank_mask:0xf
v_and_b32_dpp v134, v137, v10 row_newbcast:4 row_mask:0xf bank_mask:0xf
v_and_b32_dpp v135, v137, v11 row_newbcast:4 row_mask:0xf bank_mask:0xf
s_nop 1
v_mfma_f32_16x16x32_bf16 v[56:59], v[84:87], v[132:135], v[56:59]
s_waitcnt vmcnt(6)
buffer_load_dwordx4 v[116:119], v5, s[8:11], s29 offen offset:1024 nt
v_and_b32_dpp v128, v137, v8 row_newbcast:8 row_mask:0xf bank_mask:0xf
v_and_b32_dpp v129, v137, v9 row_newbcast:8 row_mask:0xf bank_mask:0xf
v_and_b32_dpp v130, v137, v10 row_newbcast:8 row_mask:0xf bank_mask:0xf
v_and_b32_dpp v131, v137, v11 row_newbcast:8 row_mask:0xf bank_mask:0xf
s_nop 1
v_mfma_f32_16x16x32_bf16 v[56:59], v[88:91], v[128:131], v[56:59]
s_waitcnt vmcnt(6)
buffer_load_dwordx4 v[120:123], v5, s[8:11], s29 offen offset:2048 nt
v_and_b32_dpp v132, v137, v8 row_newbcast:12 row_mask:0xf bank_mask:0xf
v_and_b32_dpp v133, v137, v9 row_newbcast:12 row_mask:0xf bank_mask:0xf
v_and_b32_dpp v134, v137, v10 row_newbcast:12 row_mask:0xf bank_mask:0xf
v_and_b32_dpp v135, v137, v11 row_newbcast:12 row_mask:0xf bank_mask:0xf
s_nop 1
v_mfma_f32_16x16x32_bf16 v[56:59], v[92:95], v[132:135], v[56:59]
s_waitcnt vmcnt(6)
buffer_load_dwordx4 v[124:127], v5, s[8:11], s29 offen offset:3072 nt
ds_read_b32 v140, v172 offset:320
s_waitcnt lgkmcnt(1)
v_fma_f32 v60, v143, s68, -v13
v_exp_f32 v60, v60
s_nop 0
v_add_f32 v6, v6, v60
v_cvt_pk_bf16_f32 v137, v60, v60
v_and_b32_dpp v128, v136, v8 row_newbcast:0 row_mask:0xf bank_mask:0xf
v_and_b32_dpp v129, v136, v9 row_newbcast:0 row_mask:0xf bank_mask:0xf
v_and_b32_dpp v130, v136, v10 row_newbcast:0 row_mask:0xf bank_mask:0xf
v_and_b32_dpp v131, v136, v11 row_newbcast:0 row_mask:0xf bank_mask:0xf
s_nop 1
v_mfma_f32_16x16x32_bf16 v[56:59], v[96:99], v[128:131], v[56:59]
s_waitcnt vmcnt(6)
s_cmp_lg_u32 s30, 2
s_cbranch_scc1 L_n28
s_mov_b64 exec, 1
v_mov_b32 v62, 1
buffer_atomic_add v62, v138, s[12:15], 0 offen sc0 sc1
s_mov_b64 exec, -1
s_mov_b64 exec, 1
v_mov_b32 v175, 1
buffer_atomic_add v175, v139, s[12:15], 0 offen sc0 sc1
s_mov_b64 exec, -1
L_n28:
s_add_u32 s27, s27, 49152
s_cmp_lg_u32 s30, 1
s_cbranch_scc1 L_nl9
s_mov_b32 s84, 0
s_mov_b32 s91, 4096
s_mov_b32 s85, s95
L_rt14:
v_readfirstlane_b32 s30, v62
s_sub_u32 s30, s30, s90
s_cmp_lt_u32 s30, 4096
s_cbranch_scc1 L_ok13
s_mov_b32 s30, 4095
s_sub_u32 s85, s85, 1
s_cbranch_scc1 L_ok13
s_mov_b64 exec, 1
v_mov_b32 v62, 1
buffer_atomic_add v62, v138, s[12:15], 0 offen sc0 sc1
s_mov_b64 exec, -1
s_waitcnt vmcnt(0)
s_branch L_rt14
L_ok13:
s_cmp_ge_u32 s30, 128
s_cbranch_scc1 L_ex10
s_mul_i32 s28, s30, 4096
s_lshr_b32 s28, s28, 16
s_mul_i32 s29, s28, 1966080
s_lshl_b32 s28, s30, 13
s_add_u32 s28, s28, s29
s_add_u32 s27, s28, s39
s_mov_b32 s27, s27
s_mov_b32 s96, s4
s_mov_b32 s97, s5
s_mov_b32 s98, s6
v_mov_b32 v173, v4
s_mov_b64 exec, 1
v_mov_b32 v62, 1
buffer_atomic_add v62, v138, s[12:15], 0 offen sc0 sc1
s_mov_b64 exec, -1
s_branch L_go12
L_ex10:
s_mov_b32 s85, s95
L_rt16:
v_readfirstlane_b32 s30, v175
s_sub_u32 s30, s30, s90
s_cmp_lt_u32 s30, 4096
s_cbranch_scc1 L_ok15
s_mov_b32 s30, 4095
s_sub_u32 s85, s85, 1
s_cbranch_scc1 L_ok15
s_mov_b64 exec, 1
v_mov_b32 v175, 1
buffer_atomic_add v175, v139, s[12:15], 0 offen sc0 sc1
s_mov_b64 exec, -1
s_waitcnt vmcnt(0)
s_branch L_rt16
L_ok15:
s_mov_b32 s84, 2
s_mov_b32 s27, s42
s_cmp_ge_u32 s30, 128
s_cbranch_scc1 L_no11
s_mov_b32 s84, 1
s_mul_i32 s28, s30, 8192
s_lshr_b32 s28, s28, 16
s_mul_i32 s29, s28, 983040
s_lshl_b32 s28, s30, 13
s_add_u32 s28, s28, s29
s_add_u32 s27, s28, s38
L_no11:
s_mov_b32 s27, s27
s_mov_b32 s96, s40
s_mov_b32 s97, s41
s_mov_b32 s98, s42
v_mov_b32 v173, v4
s_mov_b64 exec, 1
v_mov_b32 v62, 1
buffer_atomic_add v62, v139, s[12:15], 0 offen sc0 sc1
s_mov_b64 exec, -1
L_go12:
s_mov_b32 s30, 1
L_nl9:
buffer_load_dwordx4 v[64:67], v173, s[96:99], s27 offen offset:0 nt
v_and_b32_dpp v132, v136, v8 row_newbcast:4 row_mask:0xf bank_mask:0xf
v_and_b32_dpp v133, v136, v9 row_newbcast:4 row_mask:0xf bank_mask:0xf
v_and_b32_dpp v134, v136, v10 row_newbcast:4 row_mask:0xf bank_mask:0xf
v_and_b32_dpp v135, v136, v11 row_newbcast:4 row_mask:0xf bank_mask:0xf
s_nop 1
v_mfma_f32_16x16x32_bf16 v[56:59], v[100:103], v[132:135], v[56:59]
s_waitcnt vmcnt(6)
buffer_load_dwordx4 v[68:71], v173, s[96:99], s27 offen offset:1024 nt
v_and_b32_dpp v128, v136, v8 row_newbcast:8 row_mask:0xf bank_mask:0xf
v_and_b32_dpp v129, v136, v9 row_newbcast:8 row_mask:0xf bank_mask:0xf
v_and_b32_dpp v130, v136, v10 row_newbcast:8 row_mask:0xf bank_mask:0xf
v_and_b32_dpp v131, v136, v11 row_newbcast:8 row_mask:0xf bank_mask:0xf
s_nop 1
v_mfma_f32_16x16x32_bf16 v[56:59], v[104:107], v[128:131], v[56:59]
s_waitcnt vmcnt(6)
buffer_load_dwordx4 v[72:75], v173, s[96:99], s27 offen offset:2048 nt
v_and_b32_dpp v132, v136, v8 row_newbcast:12 row_mask:0xf bank_mask:0xf
v_and_b32_dpp v133, v136, v9 row_newbcast:12 row_mask:0xf bank_mask:0xf
v_and_b32_dpp v134, v136, v10 row_newbcast:12 row_mask:0xf bank_mask:0xf
v_and_b32_dpp v135, v136, v11 row_newbcast:12 row_mask:0xf bank_mask:0xf
s_nop 1
v_mfma_f32_16x16x32_bf16 v[56:59], v[108:111], v[132:135], v[56:59]
s_waitcnt vmcnt(6)
buffer_load_dwordx4 v[76:79], v173, s[96:99], s27 offen offset:3072 nt
ds_read_b32 v141, v172 offset:384
s_waitcnt lgkmcnt(1)
v_fma_f32 v60, v140, s68, -v13
v_exp_f32 v60, v60
s_nop 0
v_add_f32 v6, v6, v60
v_cvt_pk_bf16_f32 v136, v60, v60
v_and_b32_dpp v128, v137, v8 row_newbcast:0 row_mask:0xf bank_mask:0xf
v_and_b32_dpp v129, v137, v9 row_newbcast:0 row_mask:0xf bank_mask:0xf
v_and_b32_dpp v130, v137, v10 row_newbcast:0 row_mask:0xf bank_mask:0xf
v_and_b32_dpp v131, v137, v11 row_newbcast:0 row_mask:0xf bank_mask:0xf
s_nop 1
v_mfma_f32_16x16x32_bf16 v[56:59], v[112:115], v[128:131], v[56:59]
s_waitcnt vmcnt(6)
s_add_u32 s29, s27, s91
buffer_load_dwordx4 v[80:83], v173, s[96:99], s29 offen offset:0 nt
v_and_b32_dpp v132, v137, v8 row_newbcast:4 row_mask:0xf bank_mask:0xf
v_and_b32_dpp v133, v137, v9 row_newbcast:4 row_mask:0xf bank_mask:0xf
v_and_b32_dpp v134, v137, v10 row_newbcast:4 row_mask:0xf bank_mask:0xf
v_and_b32_dpp v135, v137, v11 row_newbcast:4 row_mask:0xf bank_mask:0xf
s_nop 1
v_mfma_f32_16x16x32_bf16 v[56:59], v[116:119], v[132:135], v[56:59]
s_waitcnt vmcnt(6)
buffer_load_dwordx4 v[84:87], v173, s[96:99], s29 offen offset:1024 nt
v_and_b32_dpp v128, v137, v8 row_newbcast:8 row_mask:0xf bank_mask:0xf
v_and_b32_dpp v129, v137, v9 row_newbcast:8 row_mask:0xf bank_mask:0xf
v_and_b32_dpp v130, v137, v10 row_newbcast:8 row_mask:0xf bank_mask:0xf
v_and_b32_dpp v131, v137, v11 row_newbcast:8 row_mask:0xf bank_mask:0xf
s_nop 1
v_mfma_f32_16x16x32_bf16 v[56:59], v[120:123], v[128:131], v[56:59]
s_waitcnt vmcnt(6)
buffer_load_dwordx4 v[88:91], v173, s[96:99], s29 offen offset:2048 nt
v_and_b32_dpp v132, v137, v8 row_newbcast:12 row_mask:0xf bank_mask:0xf
v_and_b32_dpp v133, v137, v9 row_newbcast:12 row_mask:0xf bank_mask:0xf
v_and_b32_dpp v134, v137, v10 row_newbcast:12 row_mask:0xf bank_mask:0xf
v_and_b32_dpp v135, v137, v11 row_newbcast:12 row_mask:0xf bank_mask:0xf
s_nop 1
v_mfma_f32_16x16x32_bf16 v[56:59], v[124:127], v[132:135], v[56:59]
v_add_u32 v172, 256, v172
s_sub_u32 s30, s30, 1
s_cmp_lg_u32 s30, 0
s_cbranch_scc1 L_vl7
s_waitcnt lgkmcnt(0)
v_mov_b32 v172, v174
s_cmp_lg_u32 s84, 0
s_cbranch_scc1 L_aend
L_dyn17:
v_mov_b32 v7, 0xff800000
s_waitcnt vmcnt(6)
s_add_u32 s29, s27, 4096
buffer_load_dwordx4 v[92:95], v4, s[4:7], s29 offen offset:3072 nt
buffer_load_dwordx4 v[96:99], v5, s[8:11], s27 offen offset:0 nt
v_mfma_f32_16x16x32_bf16 v[32:35], v[64:67], v[16:19], 0
s_waitcnt vmcnt(7)
buffer_load_dwordx4 v[100:103], v5, s[8:11], s27 offen offset:1024 nt
v_mfma_f32_16x16x32_bf16 v[32:35], v[68:71], v[20:23], v[32:35]
s_waitcnt vmcnt(7)
buffer_load_dwordx4 v[104:107], v5, s[8:11], s27 offen offset:2048 nt
v_mfma_f32_16x16x32_bf16 v[32:35], v[72:75], v[24:27], v[32:35]
s_waitcnt vmcnt(7)
buffer_load_dwordx4 v[108:111], v5, s[8:11], s27 offen offset:3072 nt
v_mfma_f32_16x16x32_bf16 v[32:35], v[76:79], v[28:31], v[32:35]
s_waitcnt vmcnt(7)
buffer_load_dwordx4 v[112:115], v5, s[8:11], s29 offen offset:0 nt
v_mfma_f32_16x16x32_bf16 v[36:39], v[80:83], v[16:19], 0
s_waitcnt vmcnt(7)
buffer_load_dwordx4 v[116:119], v5, s[8:11], s29 offen offset:1024 nt
v_mfma_f32_16x16x32_bf16 v[36:39], v[84:87], v[20:23], v[36:39]
s_waitcnt vmcnt(7)
buffer_load_dwordx4 v[120:123], v5, s[8:11], s29 offen offset:2048 nt
v_mfma_f32_16x16x32_bf16 v[36:39], v[88:91], v[24:27], v[36:39]
s_waitcnt vmcnt(7)
buffer_load_dwordx4 v[124:127], v5, s[8:11], s29 offen offset:3072 nt
v_mfma_f32_16x16x32_bf16 v[36:39], v[92:95], v[28:31], v[36:39]
s_nop 5
v_mov_b32_dpp v140, v32 quad_perm:[0,0,0,0] row_mask:0xf bank_mask:0xf
s_nop 1
v_add_f32_dpp v140, v33, v140 quad_perm:[1,1,1,1] row_mask:0xf bank_mask:0xf
s_nop 1
v_add_f32_dpp v140, v34, v140 quad_perm:[2,2,2,2] row_mask:0xf bank_mask:0xf
s_nop 1
v_add_f32_dpp v140, v35, v140 quad_perm:[3,3,3,3] row_mask:0xf bank_mask:0xf
v_cvt_pk_bf16_f32 v140, v140, v140
v_and_b32 v140, 0xffff0000, v140
v_mul_f32 v140, s69, v140
v_cvt_pk_bf16_f32 v140, v140, v140
v_and_b32 v140, 0xffff0000, v140
v_max_f32 v7, v7, v140
s_nop 7
v_mov_b32_dpp v141, v36 quad_perm:[0,0,0,0] row_mask:0xf bank_mask:0xf
s_nop 1
v_add_f32_dpp v141, v37, v141 quad_perm:[1,1,1,1] row_mask:0xf bank_mask:0xf
s_nop 1
v_add_f32_dpp v141, v38, v141 quad_perm:[2,2,2,2] row_mask:0xf bank_mask:0xf
s_nop 1
v_add_f32_dpp v141, v39, v141 quad_perm:[3,3,3,3] row_mask:0xf bank_mask:0xf
v_cvt_pk_bf16_f32 v141, v141, v141
v_and_b32 v141, 0xffff0000, v141
v_mul_f32 v141, s69, v141
v_cvt_pk_bf16_f32 v141, v141, v141
v_and_b32 v141, 0xffff0000, v141
v_max_f32 v7, v7, v141
v_cmp_gt_f32 vcc, v7, v12
s_nop 1
s_cbranch_vccz L_rs18
s_nop 1
v_max_f32_dpp v7, v7, v7 row_half_mirror row_mask:0xf bank_mask:0xf
s_nop 1
v_max_f32_dpp v7, v7, v7 row_ror:8 row_mask:0xf bank_mask:0xf
v_mov_b32 v14, v7
s_nop 1
v_permlane16_swap_b32 v7, v14
v_max_f32 v7, v7, v14
v_mov_b32 v14, v7
s_nop 1
v_permlane32_swap_b32 v7, v14
v_max_f32 v7, v7, v14
v_max_f32 v12, v12, v7
v_mul_f32 v14, s68, v12
v_sub_f32 v15, v13, v14
v_exp_f32 v15, v15
v_mov_b32 v13, v14
v_mul_f32 v6, v6, v15
v_mul_f32 v56, v56, v15
v_mul_f32 v57, v57, v15
v_mul_f32 v58, v58, v15
v_mul_f32 v59, v59, v15
L_rs18:
v_fma_f32 v60, v140, s68, -v13
v_exp_f32 v60, v60
s_nop 0
v_add_f32 v6, v6, v60
v_cvt_pk_bf16_f32 v136, v60, v60
s_waitcnt vmcnt(7)
v_fma_f32 v60, v141, s68, -v13
v_exp_f32 v60, v60
s_nop 0
v_add_f32 v6, v6, v60
v_cvt_pk_bf16_f32 v137, v60, v60
v_and_b32_dpp v128, v136, v8 row_newbcast:0 row_mask:0xf bank_mask:0xf
v_and_b32_dpp v129, v136, v9 row_newbcast:0 row_mask:0xf bank_mask:0xf
v_and_b32_dpp v130, v136, v10 row_newbcast:0 row_mask:0xf bank_mask:0xf
v_and_b32_dpp v131, v136, v11 row_newbcast:0 row_mask:0xf bank_mask:0xf
s_nop 1
v_mfma_f32_16x16x32_bf16 v[56:59], v[96:99], v[128:131], v[56:59]
s_waitcnt vmcnt(6)
s_mov_b32 s85, s95
L_rt23:
v_readfirstlane_b32 s30, v62
s_sub_u32 s30, s30, s90
s_cmp_lt_u32 s30, 4096
s_cbranch_scc1 L_ok22
s_mov_b32 s30, 4095
s_sub_u32 s85, s85, 1
s_cbranch_scc1 L_ok22
s_mov_b64 exec, 1
v_mov_b32 v62, 1
buffer_atomic_add v62, v138, s[12:15], 0 offen sc0 sc1
s_mov_b64 exec, -1
s_waitcnt vmcnt(0)
s_branch L_rt23
L_ok22:
s_cmp_ge_u32 s30, 128
s_cbranch_scc1 L_ex19
s_mul_i32 s28, s30, 4096
s_lshr_b32 s28, s28, 16
s_mul_i32 s29, s28, 1966080
s_lshl_b32 s28, s30, 13
s_add_u32 s28, s28, s29
s_add_u32 s27, s28, s39
s_mov_b32 s27, s27
s_mov_b32 s96, s4
s_mov_b32 s97, s5
s_mov_b32 s98, s6
v_mov_b32 v173, v4
s_mov_b64 exec, 1
v_mov_b32 v62, 1
buffer_atomic_add v62, v138, s[12:15], 0 offen sc0 sc1
s_mov_b64 exec, -1
s_branch L_go21
L_ex19:
s_mov_b32 s85, s95
L_rt25:
v_readfirstlane_b32 s30, v175
s_sub_u32 s30, s30, s90
s_cmp_lt_u32 s30, 4096
s_cbranch_scc1 L_ok24
s_mov_b32 s30, 4095
s_sub_u32 s85, s85, 1
s_cbranch_scc1 L_ok24
s_mov_b64 exec, 1
v_mov_b32 v175, 1
buffer_atomic_add v175, v139, s[12:15], 0 offen sc0 sc1
s_mov_b64 exec, -1
s_waitcnt vmcnt(0)
s_branch L_rt25
L_ok24:
s_mov_b32 s84, 2
s_mov_b32 s27, s42
s_cmp_ge_u32 s30, 128
s_cbranch_scc1 L_no20
s_mov_b32 s84, 1
s_mul_i32 s28, s30, 8192
s_lshr_b32 s28, s28, 16
s_mul_i32 s29, s28, 983040
s_lshl_b32 s28, s30, 13
s_add_u32 s28, s28, s29
s_add_u32 s27, s28, s38
L_no20:
s_mov_b32 s27, s27
s_mov_b32 s96, s40
s_mov_b32 s97, s41
s_mov_b32 s98, s42
v_mov_b32 v173, v4
s_mov_b64 exec, 1
v_mov_b32 v62, 1
buffer_atomic_add v62, v139, s[12:15], 0 offen sc0 sc1
s_mov_b64 exec, -1
L_go21:
buffer_load_dwordx4 v[64:67], v173, s[96:99], s27 offen offset:0 nt
v_and_b32_dpp v132, v136, v8 row_newbcast:4 row_mask:0xf bank_mask:0xf
v_and_b32_dpp v133, v136, v9 row_newbcast:4 row_mask:0xf bank_mask:0xf
v_and_b32_dpp v134, v136, v10 row_newbcast:4 row_mask:0xf bank_mask:0xf
v_and_b32_dpp v135, v136, v11 row_newbcast:4 row_mask:0xf bank_mask:0xf
s_nop 1
v_mfma_f32_16x16x32_bf16 v[56:59], v[100:103], v[132:135], v[56:59]
s_waitcnt vmcnt(7)
buffer_load_dwordx4 v[68:71], v173, s[96:99], s27 offen offset:1024 nt
v_and_b32_dpp v128, v136, v8 row_newbcast:8 row_mask:0xf bank_mask:0xf
v_and_b32_dpp v129, v136, v9 row_newbcast:8 row_mask:0xf bank_mask:0xf
v_and_b32_dpp v130, v136, v10 row_newbcast:8 row_mask:0xf bank_mask:0xf
v_and_b32_dpp v131, v136, v11 row_newbcast:8 row_mask:0xf bank_mask:0xf
s_nop 1
v_mfma_f32_16x16x32_bf16 v[56:59], v[104:107], v[128:131], v[56:59]
s_waitcnt vmcnt(7)
buffer_load_dwordx4 v[72:75], v173, s[96:99], s27 offen offset:2048 nt
v_and_b32_dpp v132, v136, v8 row_newbcast:12 row_mask:0xf bank_mask:0xf
v_and_b32_dpp v133, v136, v9 row_newbcast:12 row_mask:0xf bank_mask:0xf
v_and_b32_dpp v134, v136, v10 row_newbcast:12 row_mask:0xf bank_mask:0xf
v_and_b32_dpp v135, v136, v11 row_newbcast:12 row_mask:0xf bank_mask:0xf
s_nop 1
v_mfma_f32_16x16x32_bf16 v[56:59], v[108:111], v[132:135], v[56:59]
s_waitcnt vmcnt(7)
buffer_load_dwordx4 v[76:79], v173, s[96:99], s27 offen offset:3072 nt
v_and_b32_dpp v128, v137, v8 row_newbcast:0 row_mask:0xf bank_mask:0xf
v_and_b32_dpp v129, v137, v9 row_newbcast:0 row_mask:0xf bank_mask:0xf
v_and_b32_dpp v130, v137, v10 row_newbcast:0 row_mask:0xf bank_mask:0xf
v_and_b32_dpp v131, v137, v11 row_newbcast:0 row_mask:0xf bank_mask:0xf
s_nop 1
v_mfma_f32_16x16x32_bf16 v[56:59], v[112:115], v[128:131], v[56:59]
s_waitcnt vmcnt(7)
s_add_u32 s29, s27, s91
buffer_load_dwordx4 v[80:83], v173, s[96:99], s29 offen offset:0 nt
v_and_b32_dpp v132, v137, v8 row_newbcast:4 row_mask:0xf bank_mask:0xf
v_and_b32_dpp v133, v137, v9 row_newbcast:4 row_mask:0xf bank_mask:0xf
v_and_b32_dpp v134, v137, v10 row_newbcast:4 row_mask:0xf bank_mask:0xf
v_and_b32_dpp v135, v137, v11 row_newbcast:4 row_mask:0xf bank_mask:0xf
s_nop 1
v_mfma_f32_16x16x32_bf16 v[56:59], v[116:119], v[132:135], v[56:59]
s_waitcnt vmcnt(7)
buffer_load_dwordx4 v[84:87], v173, s[96:99], s29 offen offset:1024 nt
v_and_b32_dpp v128, v137, v8 row_newbcast:8 row_mask:0xf bank_mask:0xf
v_and_b32_dpp v129, v137, v9 row_newbcast:8 row_mask:0xf bank_mask:0xf
v_and_b32_dpp v130, v137, v10 row_newbcast:8 row_mask:0xf bank_mask:0xf
v_and_b32_dpp v131, v137, v11 row_newbcast:8 row_mask:0xf bank_mask:0xf
s_nop 1
v_mfma_f32_16x16x32_bf16 v[56:59], v[120:123], v[128:131], v[56:59]
s_waitcnt vmcnt(7)
buffer_load_dwordx4 v[88:91], v173, s[96:99], s29 offen offset:2048 nt
v_and_b32_dpp v132, v137, v8 row_newbcast:12 row_mask:0xf bank_mask:0xf
v_and_b32_dpp v133, v137, v9 row_newbcast:12 row_mask:0xf bank_mask:0xf
v_and_b32_dpp v134, v137, v10 row_newbcast:12 row_mask:0xf bank_mask:0xf
v_and_b32_dpp v135, v137, v11 row_newbcast:12 row_mask:0xf bank_mask:0xf
s_nop 1
v_mfma_f32_16x16x32_bf16 v[56:59], v[124:127], v[132:135], v[56:59]
s_cmp_eq_u32 s84, 0
s_cbranch_scc1 L_dyn17
L_aend:
s_cmp_eq_u32 s84, 2
s_cbranch_scc1 L_bend
L_dyn26:
v_mov_b32 v7, 0xff800000
s_waitcnt vmcnt(6)
s_add_u32 s29, s27, 4096
buffer_load_dwordx4 v[92:95], v4, s[40:43], s29 offen offset:3072 nt
buffer_load_dwordx4 v[96:99], v5, s[44:47], s27 offen offset:0 nt
v_mfma_f32_16x16x32_bf16 v[32:35], v[64:67], v[40:43], 0
s_waitcnt vmcnt(7)
buffer_load_dwordx4 v[100:103], v5, s[44:47], s27 offen offset:1024 nt
v_mfma_f32_16x16x32_bf16 v[32:35], v[68:71], v[44:47], v[32:35]
s_waitcnt vmcnt(7)
buffer_load_dwordx4 v[104:107], v5, s[44:47], s27 offen offset:2048 nt
v_mfma_f32_16x16x32_bf16 v[36:39], v[72:75], v[40:43], 0
s_waitcnt vmcnt(7)
buffer_load_dwordx4 v[108:111], v5, s[44:47], s27 offen offset:3072 nt
v_mfma_f32_16x16x32_bf16 v[36:39], v[76:79], v[44:47], v[36:39]
s_nop 5
v_mov_b32_dpp v140, v32 quad_perm:[0,0,0,0] row_mask:0xf bank_mask:0xf
s_nop 1
v_add_f32_dpp v140, v33, v140 quad_perm:[1,1,1,1] row_mask:0xf bank_mask:0xf
s_nop 1
v_add_f32_dpp v140, v34, v140 quad_perm:[2,2,2,2] row_mask:0xf bank_mask:0xf
s_nop 1
v_add_f32_dpp v140, v35, v140 quad_perm:[3,3,3,3] row_mask:0xf bank_mask:0xf
v_cvt_pk_bf16_f32 v140, v140, v140
v_and_b32 v140, 0xffff0000, v140
v_mul_f32 v140, s69, v140
v_cvt_pk_bf16_f32 v140, v140, v140
v_and_b32 v140, 0xffff0000, v140
v_max_f32 v7, v7, v140
s_waitcnt vmcnt(7)
buffer_load_dwordx4 v[112:115], v5, s[44:47], s29 offen offset:0 nt
v_mfma_f32_16x16x32_bf16 v[32:35], v[80:83], v[40:43], 0
s_waitcnt vmcnt(7)
buffer_load_dwordx4 v[116:119], v5, s[44:47], s29 offen offset:1024 nt
v_mfma_f32_16x16x32_bf16 v[32:35], v[84:87], v[44:47], v[32:35]
s_nop 5
v_mov_b32_dpp v141, v36 quad_perm:[0,0,0,0] row_mask:0xf bank_mask:0xf
s_nop 1
v_add_f32_dpp v141, v37, v141 quad_perm:[1,1,1,1] row_mask:0xf bank_mask:0xf
s_nop 1
v_add_f32_dpp v141, v38, v141 quad_perm:[2,2,2,2] row_mask:0xf bank_mask:0xf
s_nop 1
v_add_f32_dpp v141, v39, v141 quad_perm:[3,3,3,3] row_mask:0xf bank_mask:0xf
v_cvt_pk_bf16_f32 v141, v141, v141
v_and_b32 v141, 0xffff0000, v141
v_mul_f32 v141, s69, v141
v_cvt_pk_bf16_f32 v141, v141, v141
v_and_b32 v141, 0xffff0000, v141
v_max_f32 v7, v7, v141
s_waitcnt vmcnt(7)
buffer_load_dwordx4 v[120:123], v5, s[44:47], s29 offen offset:2048 nt
v_mfma_f32_16x16x32_bf16 v[36:39], v[88:91], v[40:43], 0
s_waitcnt vmcnt(7)
buffer_load_dwordx4 v[124:127], v5, s[44:47], s29 offen offset:3072 nt
v_mfma_f32_16x16x32_bf16 v[36:39], v[92:95], v[44:47], v[36:39]
s_nop 5
v_mov_b32_dpp v142, v32 quad_perm:[0,0,0,0] row_mask:0xf bank_mask:0xf
s_nop 1
v_add_f32_dpp v142, v33, v142 quad_perm:[1,1,1,1] row_mask:0xf bank_mask:0xf
s_nop 1
v_add_f32_dpp v142, v34, v142 quad_perm:[2,2,2,2] row_mask:0xf bank_mask:0xf
s_nop 1
v_add_f32_dpp v142, v35, v142 quad_perm:[3,3,3,3] row_mask:0xf bank_mask:0xf
v_cvt_pk_bf16_f32 v142, v142, v142
v_and_b32 v142, 0xffff0000, v142
v_mul_f32 v142, s69, v142
v_cvt_pk_bf16_f32 v142, v142, v142
v_and_b32 v142, 0xffff0000, v142
v_max_f32 v7, v7, v142
s_nop 7
v_mov_b32_dpp v143, v36 quad_perm:[0,0,0,0] row_mask:0xf bank_mask:0xf
s_nop 1
v_add_f32_dpp v143, v37, v143 quad_perm:[1,1,1,1] row_mask:0xf bank_mask:0xf
s_nop 1
v_add_f32_dpp v143, v38, v143 quad_perm:[2,2,2,2] row_mask:0xf bank_mask:0xf
s_nop 1
v_add_f32_dpp v143, v39, v143 quad_perm:[3,3,3,3] row_mask:0xf bank_mask:0xf
v_cvt_pk_bf16_f32 v143, v143, v143
v_and_b32 v143, 0xffff0000, v143
v_mul_f32 v143, s69, v143
v_cvt_pk_bf16_f32 v143, v143, v143
v_and_b32 v143, 0xffff0000, v143
v_max_f32 v7, v7, v143
v_cmp_gt_f32 vcc, v7, v53
s_nop 1
s_cbranch_vccz L_rs27
s_nop 1
v_max_f32_dpp v7, v7, v7 row_half_mirror row_mask:0xf bank_mask:0xf
v_mov_b32 v14, v7
s_nop 1
v_permlane16_swap_b32 v7, v14
v_max_f32 v7, v7, v14
v_mov_b32 v14, v7
s_nop 1
v_permlane32_swap_b32 v7, v14
v_max_f32 v7, v7, v14
v_max_f32 v53, v53, v7
v_mul_f32 v14, s68, v53
v_sub_f32 v15, v54, v14
v_exp_f32 v15, v15
v_mov_b32 v54, v14
v_mul_f32 v52, v52, v15
v_mul_f32 v48, v48, v15
v_mul_f32 v49, v49, v15
v_mul_f32 v50, v50, v15
v_mul_f32 v51, v51, v15
L_rs27:
v_fma_f32 v60, v140, s68, -v54
v_exp_f32 v60, v60
s_nop 0
v_add_f32 v52, v52, v60
v_cvt_pk_bf16_f32 v136, v60, v60
s_waitcnt vmcnt(7)
v_fma_f32 v60, v141, s68, -v54
v_exp_f32 v60, v60
s_nop 0
v_add_f32 v52, v52, v60
v_cvt_pk_bf16_f32 v137, v60, v60
v_and_b32 v128, v136, v8
v_and_b32 v129, v136, v9
v_and_b32_dpp v130, v136, v10 row_half_mirror row_mask:0xf bank_mask:0xf
v_and_b32_dpp v131, v136, v11 row_half_mirror row_mask:0xf bank_mask:0xf
s_nop 1
v_mfma_f32_16x16x32_bf16 v[48:51], v[96:99], v[128:131], v[48:51]
s_waitcnt vmcnt(6)
s_mov_b32 s85, s95
L_rt29:
v_readfirstlane_b32 s30, v62
s_sub_u32 s30, s30, s90
s_cmp_lt_u32 s30, 4096
s_cbranch_scc1 L_ok28
s_mov_b32 s30, 4095
s_sub_u32 s85, s85, 1
s_cbranch_scc1 L_ok28
s_mov_b64 exec, 1
v_mov_b32 v62, 1
buffer_atomic_add v62, v139, s[12:15], 0 offen sc0 sc1
s_mov_b64 exec, -1
s_waitcnt vmcnt(0)
s_branch L_rt29
L_ok28:
s_add_u32 s30, s30, 0
s_cmp_ge_u32 s30, 128
s_cbranch_scc1 L_ex30
s_mul_i32 s28, s30, 8192
s_lshr_b32 s28, s28, 16
s_mul_i32 s29, s28, 983040
s_lshl_b32 s28, s30, 13
s_add_u32 s28, s28, s29
s_add_u32 s27, s28, s38
s_mov_b64 exec, 1
v_mov_b32 v62, 1
buffer_atomic_add v62, v139, s[12:15], 0 offen sc0 sc1
s_mov_b64 exec, -1
s_branch L_go31
L_ex30:
s_mov_b32 s27, s42
s_mov_b64 exec, 1
v_mov_b32 v62, 1
buffer_atomic_add v62, v139, s[12:15], 0 offen sc0 sc1
s_mov_b64 exec, -1
L_go31:
buffer_load_dwordx4 v[64:67], v173, s[96:99], s27 offen offset:0 nt
v_and_b32_dpp v132, v136, v8 row_half_mirror row_mask:0xf bank_mask:0xf
v_and_b32_dpp v133, v136, v9 row_half_mirror row_mask:0xf bank_mask:0xf
v_and_b32 v134, v136, v10
v_and_b32 v135, v136, v11
s_nop 1
v_mfma_f32_16x16x32_bf16 v[48:51], v[100:103], v[132:135], v[48:51]
s_waitcnt vmcnt(7)
buffer_load_dwordx4 v[68:71], v173, s[96:99], s27 offen offset:1024 nt
v_fma_f32 v60, v142, s68, -v54
v_exp_f32 v60, v60
s_nop 0
v_add_f32 v52, v52, v60
v_cvt_pk_bf16_f32 v136, v60, v60
v_and_b32 v128, v137, v8
v_and_b32 v129, v137, v9
v_and_b32_dpp v130, v137, v10 row_half_mirror row_mask:0xf bank_mask:0xf
v_and_b32_dpp v131, v137, v11 row_half_mirror row_mask:0xf bank_mask:0xf
s_nop 1
v_mfma_f32_16x16x32_bf16 v[48:51], v[104:107], v[128:131], v[48:51]
s_waitcnt vmcnt(7)
buffer_load_dwordx4 v[72:75], v173, s[96:99], s27 offen offset:2048 nt
v_and_b32_dpp v132, v137, v8 row_half_mirror row_mask:0xf bank_mask:0xf
v_and_b32_dpp v133, v137, v9 row_half_mirror row_mask:0xf bank_mask:0xf
v_and_b32 v134, v137, v10
v_and_b32 v135, v137, v11
s_nop 1
v_mfma_f32_16x16x32_bf16 v[48:51], v[108:111], v[132:135], v[48:51]
s_waitcnt vmcnt(7)
buffer_load_dwordx4 v[76:79], v173, s[96:99], s27 offen offset:3072 nt
v_fma_f32 v60, v143, s68, -v54
v_exp_f32 v60, v60
s_nop 0
v_add_f32 v52, v52, v60
v_cvt_pk_bf16_f32 v137, v60, v60
v_and_b32 v128, v136, v8
v_and_b32 v129, v136, v9
v_and_b32_dpp v130, v136, v10 row_half_mirror row_mask:0xf bank_mask:0xf
v_and_b32_dpp v131, v136, v11 row_half_mirror row_mask:0xf bank_mask:0xf
s_nop 1
v_mfma_f32_16x16x32_bf16 v[48:51], v[112:115], v[128:131], v[48:51]
s_waitcnt vmcnt(7)
s_add_u32 s29, s27, s91
buffer_load_dwordx4 v[80:83], v173, s[96:99], s29 offen offset:0 nt
v_and_b32_dpp v132, v136, v8 row_half_mirror row_mask:0xf bank_mask:0xf
v_and_b32_dpp v133, v136, v9 row_half_mirror row_mask:0xf bank_mask:0xf
v_and_b32 v134, v136, v10
v_and_b32 v135, v136, v11
s_nop 1
v_mfma_f32_16x16x32_bf16 v[48:51], v[116:119], v[132:135], v[48:51]
s_waitcnt vmcnt(7)
buffer_load_dwordx4 v[84:87], v173, s[96:99], s29 offen offset:1024 nt
v_and_b32 v128, v137, v8
v_and_b32 v129, v137, v9
v_and_b32_dpp v130, v137, v10 row_half_mirror row_mask:0xf bank_mask:0xf
v_and_b32_dpp v131, v137, v11 row_half_mirror row_mask:0xf bank_mask:0xf
s_nop 1
v_mfma_f32_16x16x32_bf16 v[48:51], v[120:123], v[128:131], v[48:51]
s_waitcnt vmcnt(7)
buffer_load_dwordx4 v[88:91], v173, s[96:99], s29 offen offset:2048 nt
v_and_b32_dpp v132, v137, v8 row_half_mirror row_mask:0xf bank_mask:0xf
v_and_b32_dpp v133, v137, v9 row_half_mirror row_mask:0xf bank_mask:0xf
v_and_b32 v134, v137, v10
v_and_b32 v135, v137, v11
s_nop 1
v_mfma_f32_16x16x32_bf16 v[48:51], v[124:127], v[132:135], v[48:51]
s_cmp_lt_u32 s30, 128
s_cbranch_scc1 L_dyn26
L_bend:
s_nop 7
s_nop 1
v_add_f32_dpp v6, v6, v6 row_ror:4 row_mask:0xf bank_mask:0xf
s_nop 1
v_add_f32_dpp v6, v6, v6 row_ror:8 row_mask:0xf bank_mask:0xf
v_mov_b32 v14, v6
s_nop 1
v_permlane16_swap_b32 v6, v14
v_add_f32 v6, v6, v14
v_mov_b32 v14, v6
s_nop 1
v_permlane32_swap_b32 v6, v14
v_add_f32 v6, v6, v14
s_nop 1
v_add_f32_dpp v52, v52, v52 row_half_mirror row_mask:0xf bank_mask:0xf
v_mov_b32 v14, v52
s_nop 1
v_permlane16_swap_b32 v52, v14
v_add_f32 v52, v52, v14
v_mov_b32 v14, v52
s_nop 1
v_permlane32_swap_b32 v52, v14
v_add_f32 v52, v52, v14
s_waitcnt vmcnt(0)
v_add_u32 v14, s93, v5
v_mov_b32 v64, v13
v_mov_b32 v65, v6
v_mov_b32 v66, v54
v_mov_b32 v67, v52
ds_write_b128 v14, v[56:59]
ds_write_b128 v14, v[48:51] offset:1024
ds_write_b128 v14, v[64:67] offset:2048
s_lshl_b32 s33, s3, 8
s_add_u32 s33, s33, s2
s_add_u32 s33, s33, 256
s_cmp_ge_u32 s33, 576
s_cbranch_scc1 L_nt
s_mul_i32 s28, s33, 7282
s_lshr_b32 s28, s28, 16
s_mul_i32 s29, s28, 9
s_sub_u32 s32, s33, s29
s_mov_b32 s33, s28
s_cmp_ge_u32 s33, 32
s_cselect_b32 s16, s58, s48
s_cselect_b32 s17, s59, s49
s_and_b32 s17, s17, 0xffff
s_and_b32 s28, s33, 31
s_mul_i32 s28, s28, 147456
s_lshl_b32 s29, s32, 7
s_add_u32 s28, s28, s29
v_lshrrev_b32 v14, 3, v0
v_mul_u32_u24 v14, 18432, v14
v_and_b32 v15, 7, v0
v_lshl_add_u32 v14, v15, 4, v14
buffer_load_dwordx4 a[0:3], v14, s[16:19], s28 offen offset:0 nt
buffer_load_dwordx4 a[4:7], v14, s[16:19], s28 offen offset:1152 nt
buffer_load_dwordx4 a[8:11], v14, s[16:19], s28 offen offset:2304 nt
buffer_load_dwordx4 a[12:15], v14, s[16:19], s28 offen offset:3456 nt
s_add_u32 s28, s28, 4608
buffer_load_dwordx4 a[16:19], v14, s[16:19], s28 offen offset:0 nt
buffer_load_dwordx4 a[20:23], v14, s[16:19], s28 offen offset:1152 nt
buffer_load_dwordx4 a[24:27], v14, s[16:19], s28 offen offset:2304 nt
buffer_load_dwordx4 a[28:31], v14, s[16:19], s28 offen offset:3456 nt
s_add_u32 s28, s28, 4608
buffer_load_dwordx4 a[32:35], v14, s[16:19], s28 offen offset:0 nt
buffer_load_dwordx4 a[36:39], v14, s[16:19], s28 offen offset:1152 nt
buffer_load_dwordx4 a[40:43], v14, s[16:19], s28 offen offset:2304 nt
buffer_load_dwordx4 a[44:47], v14, s[16:19], s28 offen offset:3456 nt
s_add_u32 s28, s28, 4608
buffer_load_dwordx4 a[48:51], v14, s[16:19], s28 offen offset:0 nt
buffer_load_dwordx4 a[52:55], v14, s[16:19], s28 offen offset:1152 nt
buffer_load_dwordx4 a[56:59], v14, s[16:19], s28 offen offset:2304 nt
buffer_load_dwordx4 a[60:63], v14, s[16:19], s28 offen offset:3456 nt
L_nt:
s_waitcnt lgkmcnt(0)
s_barrier
s_cmp_eq_u32 s3, 0
s_cbranch_scc1 L_task
s_sub_u32 s28, s3, 1
s_lshl_b32 s29, s28, 10
v_add_u32 v14, s29, v5
s_lshl_b32 s29, s28, 3
v_add_u32 v15, s29, v5
ds_read_b128 v[64:67], v14 offset:2304
ds_read_b64 v[80:81], v15 offset:4352
ds_read_b128 v[68:71], v14 offset:12800
ds_read_b64 v[82:83], v15 offset:14848
ds_read_b128 v[72:75], v14 offset:23296
ds_read_b64 v[84:85], v15 offset:25344
s_waitcnt lgkmcnt(0)
v_max3_f32 v92, v80, v82, v84
v_sub_f32 v80, v80, v92
v_exp_f32 v80, v80
v_sub_f32 v82, v82, v92
v_exp_f32 v82, v82
v_sub_f32 v84, v84, v92
v_exp_f32 v84, v84
v_mov_b32 v93, s31
v_mul_f32 v94, v80, v81
v_fmac_f32 v94, v82, v83
v_fmac_f32 v94, v84, v85
v_mov_b32 v95, s31
v_mul_f32 v96, v80, v64
v_fmac_f32 v96, v82, v68
v_fmac_f32 v96, v84, v72
v_min_u32 v96, -2, v96
v_mul_f32 v97, v80, v65
v_fmac_f32 v97, v82, v69
v_fmac_f32 v97, v84, v73
v_min_u32 v97, -2, v97
v_mul_f32 v98, v80, v66
v_fmac_f32 v98, v82, v70
v_fmac_f32 v98, v84, v74
v_min_u32 v98, -2, v98
v_mul_f32 v99, v80, v67
v_fmac_f32 v99, v82, v71
v_fmac_f32 v99, v84, v75
v_min_u32 v99, -2, v99
v_lshlrev_b32 v14, 5, v2
s_lshl_b32 s28, s87, 9
s_add_u32 s28, s28, 262144
s_lshl_b32 s29, s87, 4
s_add_u32 s29, s29, 786432
s_mov_b64 exec, s[88:89]
buffer_store_dwordx4 v[96:99], v63, s[12:15], s28 offen sc1
s_and_b32 s88, s88, 0x101
s_mov_b32 s89, 0
s_mov_b64 exec, s[88:89]
buffer_store_dwordx4 v[92:95], v14, s[12:15], s29 offen sc1
s_mov_b64 exec, -1
s_cmp_eq_u32 s3, 2
s_cbranch_scc1 L_final
s_cmp_ge_u32 s2, 64
s_cbranch_scc1 L_fin
s_branch L_task
L_helper:
s_lshr_b32 s24, s2, 2
s_and_b32 s25, s2, 3
s_cmp_ge_u32 s24, 32
s_cselect_b32 s16, s56, s46
s_cselect_b32 s17, s57, s47
s_cselect_b32 s20, s50, s40
s_cselect_b32 s21, s51, s41
s_and_b32 s17, s17, 0xffff
s_and_b32 s21, s21, 0xffff
s_mov_b32 s22, 1152
s_mov_b32 s18, 4718592
s_mov_b32 s19, 0x20000
s_mov_b32 s23, 0x20000
v_mov_b32 v60, 0
s_cmp_lg_u32 s2, 0
s_cbranch_scc1 L_h1
s_memrealtime s[36:37]
s_waitcnt lgkmcnt(0)
s_mul_i32 s37, s37, 0x9e3779b1
s_xor_b32 s31, s36, s37
s_lshl_b32 s31, s31, 1
s_or_b32 s31, s31, 1
v_mov_b32 v82, s31
v_mov_b32 v83, 0
s_mov_b64 exec, 1
global_atomic_cmpswap v60, v[82:83], s[62:63] sc1
s_mov_b64 exec, -1
L_h1:
global_load_dword v61, v60, s[62:63] sc1
v_mul_u32_u24 v14, 72, v3
s_mul_i32 s28, s25, 288
buffer_load_dwordx4 v[64:67], v14, s[20:23], s28 offen offset:0
buffer_load_dwordx4 v[68:71], v14, s[20:23], s28 offen offset:16
buffer_load_dwordx4 v[72:75], v14, s[20:23], s28 offen offset:32
buffer_load_dwordx4 v[76:79], v14, s[20:23], s28 offen offset:48
buffer_load_dwordx2 v[80:81], v14, s[20:23], s28 offen offset:64
v_mul_u32_u24 v15, 294912, v3
v_lshl_add_u32 v15, v2, 4, v15
s_mul_i32 s28, s25, 1179648
s_and_b32 s29, s24, 31
s_lshl_b32 s29, s29, 8
s_add_u32 s28, s28, s29
buffer_load_dwordx4 v[100:103], v15, s[16:19], s28 offen nt
s_add_u32 s28, s28, 8192
buffer_load_dwordx4 v[104:107], v15, s[16:19], s28 offen nt
s_add_u32 s28, s28, 8192
buffer_load_dwordx4 v[108:111], v15, s[16:19], s28 offen nt
s_add_u32 s28, s28, 8192
buffer_load_dwordx4 v[112:115], v15, s[16:19], s28 offen nt
s_add_u32 s28, s28, 8192
buffer_load_dwordx4 v[116:119], v15, s[16:19], s28 offen nt
s_add_u32 s28, s28, 8192
buffer_load_dwordx4 v[120:123], v15, s[16:19], s28 offen nt
s_add_u32 s28, s28, 8192
buffer_load_dwordx4 v[124:127], v15, s[16:19], s28 offen nt
s_add_u32 s28, s28, 8192
buffer_load_dwordx4 v[128:131], v15, s[16:19], s28 offen nt
s_add_u32 s28, s28, 8192
buffer_load_dwordx4 v[132:135], v15, s[16:19], s28 offen nt
s_add_u32 s28, s28, 8192
buffer_load_dwordx4 v[136:139], v15, s[16:19], s28 offen nt
s_add_u32 s28, s28, 8192
buffer_load_dwordx4 v[140:143], v15, s[16:19], s28 offen nt
s_add_u32 s28, s28, 8192
buffer_load_dwordx4 v[144:147], v15, s[16:19], s28 offen nt
s_add_u32 s28, s28, 8192
buffer_load_dwordx4 v[148:151], v15, s[16:19], s28 offen nt
s_add_u32 s28, s28, 8192
buffer_load_dwordx4 v[152:155], v15, s[16:19], s28 offen nt
s_add_u32 s28, s28, 8192
buffer_load_dwordx4 v[156:159], v15, s[16:19], s28 offen nt
s_add_u32 s28, s28, 8192
buffer_load_dwordx4 v[160:163], v15, s[16:19], s28 offen nt
s_add_u32 s28, s28, 8192
buffer_load_dwordx4 v[164:167], v15, s[16:19], s28 offen nt
s_add_u32 s28, s28, 8192
buffer_load_dwordx4 v[168:171], v15, s[16:19], s28 offen nt
s_add_u32 s28, s28, 8192
buffer_load_dwordx4 v[172:175], v15, s[16:19], s28 offen nt
s_add_u32 s28, s28, 8192
buffer_load_dwordx4 v[176:179], v15, s[16:19], s28 offen nt
s_add_u32 s28, s28, 8192
buffer_load_dwordx4 v[180:183], v15, s[16:19], s28 offen nt
s_add_u32 s28, s28, 8192
buffer_load_dwordx4 v[184:187], v15, s[16:19], s28 offen nt
s_add_u32 s28, s28, 8192
buffer_load_dwordx4 v[188:191], v15, s[16:19], s28 offen nt
s_add_u32 s28, s28, 8192
buffer_load_dwordx4 v[192:195], v15, s[16:19], s28 offen nt
s_add_u32 s28, s28, 8192
buffer_load_dwordx4 v[196:199], v15, s[16:19], s28 offen nt
s_add_u32 s28, s28, 8192
buffer_load_dwordx4 v[200:203], v15, s[16:19], s28 offen nt
s_add_u32 s28, s28, 8192
buffer_load_dwordx4 v[204:207], v15, s[16:19], s28 offen nt
s_add_u32 s28, s28, 8192
buffer_load_dwordx4 v[208:211], v15, s[16:19], s28 offen nt
s_add_u32 s28, s28, 8192
buffer_load_dwordx4 v[212:215], v15, s[16:19], s28 offen nt
s_add_u32 s28, s28, 8192
buffer_load_dwordx4 v[216:219], v15, s[16:19], s28 offen nt
s_add_u32 s28, s28, 8192
buffer_load_dwordx4 v[220:223], v15, s[16:19], s28 offen nt
s_add_u32 s28, s28, 8192
buffer_load_dwordx4 v[224:227], v15, s[16:19], s28 offen nt
s_add_u32 s28, s28, 8192
buffer_load_dwordx4 v[228:231], v15, s[16:19], s28 offen nt
s_add_u32 s28, s28, 8192
buffer_load_dwordx4 v[232:235], v15, s[16:19], s28 offen nt
s_add_u32 s28, s28, 8192
buffer_load_dwordx4 v[236:239], v15, s[16:19], s28 offen nt
s_add_u32 s28, s28, 8192
buffer_load_dwordx4 v[240:243], v15, s[16:19], s28 offen nt
s_add_u32 s28, s28, 8192
v_and_b32 v14, 1, v0
v_lshlrev_b32 v14, 4, v14
v_mov_b32 v15, 0xffff
v_lshlrev_b32 v14, v14, v15
v_bfe_u32 v15, v0, 1, 2
v_cmp_eq_u32 vcc, 0, v15
s_nop 1
v_cndmask_b32 v8, 0, v14, vcc
v_cmp_eq_u32 vcc, 1, v15
s_nop 1
v_cndmask_b32 v9, 0, v14, vcc
v_cmp_eq_u32 vcc, 2, v15
s_nop 1
v_cndmask_b32 v10, 0, v14, vcc
v_cmp_eq_u32 vcc, 3, v15
s_nop 1
v_cndmask_b32 v11, 0, v14, vcc
s_mov_b32 s66, 0x01000100
s_mov_b32 s67, 0x03020302
s_mov_b32 s12, s64
s_and_b32 s13, s65, 0xffff
s_mov_b32 s14, 1376256
s_mov_b32 s15, 0x20000
s_mov_b32 s18, 4718592
s_mov_b32 s19, 0x20000
s_mov_b32 s23, 0x20000
s_mov_b32 s95, 131072
s_mov_b32 s94, 0
s_waitcnt vmcnt(35)
v_perm_b32 v60, v64, v64, s66
v_and_b32 v84, v60, v8
v_and_b32 v85, v60, v9
v_and_b32 v86, v60, v10
v_and_b32 v87, v60, v11
s_nop 1
v_mfma_f32_16x16x32_bf16 v[56:59], v[100:103], v[84:87], 0
s_waitcnt vmcnt(34)
v_perm_b32 v60, v64, v64, s67
v_and_b32 v88, v60, v8
v_and_b32 v89, v60, v9
v_and_b32 v90, v60, v10
v_and_b32 v91, v60, v11
s_nop 1
v_mfma_f32_16x16x32_bf16 v[56:59], v[104:107], v[88:91], v[56:59]
s_waitcnt vmcnt(33)
v_perm_b32 v60, v65, v65, s66
v_and_b32 v84, v60, v8
v_and_b32 v85, v60, v9
v_and_b32 v86, v60, v10
v_and_b32 v87, v60, v11
s_nop 1
v_mfma_f32_16x16x32_bf16 v[56:59], v[108:111], v[84:87], v[56:59]
s_waitcnt vmcnt(32)
v_perm_b32 v60, v65, v65, s67
v_and_b32 v88, v60, v8
v_and_b32 v89, v60, v9
v_and_b32 v90, v60, v10
v_and_b32 v91, v60, v11
s_nop 1
v_mfma_f32_16x16x32_bf16 v[56:59], v[112:115], v[88:91], v[56:59]
s_waitcnt vmcnt(31)
v_perm_b32 v60, v66, v66, s66
v_and_b32 v84, v60, v8
v_and_b32 v85, v60, v9
v_and_b32 v86, v60, v10
v_and_b32 v87, v60, v11
s_nop 1
v_mfma_f32_16x16x32_bf16 v[56:59], v[116:119], v[84:87], v[56:59]
s_waitcnt vmcnt(30)
v_perm_b32 v60, v66, v66, s67
v_and_b32 v88, v60, v8
v_and_b32 v89, v60, v9
v_and_b32 v90, v60, v10
v_and_b32 v91, v60, v11
s_nop 1
v_mfma_f32_16x16x32_bf16 v[56:59], v[120:123], v[88:91], v[56:59]
s_waitcnt vmcnt(29)
v_perm_b32 v60, v67, v67, s66
v_and_b32 v84, v60, v8
v_and_b32 v85, v60, v9
v_and_b32 v86, v60, v10
v_and_b32 v87, v60, v11
s_nop 1
v_mfma_f32_16x16x32_bf16 v[56:59], v[124:127], v[84:87], v[56:59]
s_waitcnt vmcnt(28)
v_perm_b32 v60, v67, v67, s67
v_and_b32 v88, v60, v8
v_and_b32 v89, v60, v9
v_and_b32 v90, v60, v10
v_and_b32 v91, v60, v11
s_nop 1
v_mfma_f32_16x16x32_bf16 v[56:59], v[128:131], v[88:91], v[56:59]
s_waitcnt vmcnt(27)
v_perm_b32 v60, v68, v68, s66
v_and_b32 v84, v60, v8
v_and_b32 v85, v60, v9
v_and_b32 v86, v60, v10
v_and_b32 v87, v60, v11
s_nop 1
v_mfma_f32_16x16x32_bf16 v[56:59], v[132:135], v[84:87], v[56:59]
s_waitcnt vmcnt(26)
v_perm_b32 v60, v68, v68, s67
v_and_b32 v88, v60, v8
v_and_b32 v89, v60, v9
v_and_b32 v90, v60, v10
v_and_b32 v91, v60, v11
s_nop 1
v_mfma_f32_16x16x32_bf16 v[56:59], v[136:139], v[88:91], v[56:59]
s_waitcnt vmcnt(25)
v_perm_b32 v60, v69, v69, s66
v_and_b32 v84, v60, v8
v_and_b32 v85, v60, v9
v_and_b32 v86, v60, v10
v_and_b32 v87, v60, v11
s_nop 1
v_mfma_f32_16x16x32_bf16 v[56:59], v[140:143], v[84:87], v[56:59]
s_waitcnt vmcnt(24)
v_perm_b32 v60, v69, v69, s67
v_and_b32 v88, v60, v8
v_and_b32 v89, v60, v9
v_and_b32 v90, v60, v10
v_and_b32 v91, v60, v11
s_nop 1
v_mfma_f32_16x16x32_bf16 v[56:59], v[144:147], v[88:91], v[56:59]
s_waitcnt vmcnt(23)
v_perm_b32 v60, v70, v70, s66
v_and_b32 v84, v60, v8
v_and_b32 v85, v60, v9
v_and_b32 v86, v60, v10
v_and_b32 v87, v60, v11
s_nop 1
v_mfma_f32_16x16x32_bf16 v[56:59], v[148:151], v[84:87], v[56:59]
s_waitcnt vmcnt(22)
v_perm_b32 v60, v70, v70, s67
v_and_b32 v88, v60, v8
v_and_b32 v89, v60, v9
v_and_b32 v90, v60, v10
v_and_b32 v91, v60, v11
s_nop 1
v_mfma_f32_16x16x32_bf16 v[56:59], v[152:155], v[88:91], v[56:59]
s_waitcnt vmcnt(21)
v_perm_b32 v60, v71, v71, s66
v_and_b32 v84, v60, v8
v_and_b32 v85, v60, v9
v_and_b32 v86, v60, v10
v_and_b32 v87, v60, v11
s_nop 1
v_mfma_f32_16x16x32_bf16 v[56:59], v[156:159], v[84:87], v[56:59]
s_waitcnt vmcnt(20)
v_perm_b32 v60, v71, v71, s67
v_and_b32 v88, v60, v8
v_and_b32 v89, v60, v9
v_and_b32 v90, v60, v10
v_and_b32 v91, v60, v11
s_nop 1
v_mfma_f32_16x16x32_bf16 v[56:59], v[160:163], v[88:91], v[56:59]
s_waitcnt vmcnt(19)
v_perm_b32 v60, v72, v72, s66
v_and_b32 v84, v60, v8
v_and_b32 v85, v60, v9
v_and_b32 v86, v60, v10
v_and_b32 v87, v60, v11
s_nop 1
v_mfma_f32_16x16x32_bf16 v[56:59], v[164:167], v[84:87], v[56:59]
s_waitcnt vmcnt(18)
v_perm_b32 v60, v72, v72, s67
v_and_b32 v88, v60, v8
v_and_b32 v89, v60, v9
v_and_b32 v90, v60, v10
v_and_b32 v91, v60, v11
s_nop 1
v_mfma_f32_16x16x32_bf16 v[56:59], v[168:171], v[88:91], v[56:59]
s_waitcnt vmcnt(17)
v_perm_b32 v60, v73, v73, s66
v_and_b32 v84, v60, v8
v_and_b32 v85, v60, v9
v_and_b32 v86, v60, v10
v_and_b32 v87, v60, v11
s_nop 1
v_mfma_f32_16x16x32_bf16 v[56:59], v[172:175], v[84:87], v[56:59]
s_waitcnt vmcnt(16)
v_perm_b32 v60, v73, v73, s67
v_and_b32 v88, v60, v8
v_and_b32 v89, v60, v9
v_and_b32 v90, v60, v10
v_and_b32 v91, v60, v11
s_nop 1
v_mfma_f32_16x16x32_bf16 v[56:59], v[176:179], v[88:91], v[56:59]
s_waitcnt vmcnt(15)
v_perm_b32 v60, v74, v74, s66
v_and_b32 v84, v60, v8
v_and_b32 v85, v60, v9
v_and_b32 v86, v60, v10
v_and_b32 v87, v60, v11
s_nop 1
v_mfma_f32_16x16x32_bf16 v[56:59], v[180:183], v[84:87], v[56:59]
s_waitcnt vmcnt(14)
v_perm_b32 v60, v74, v74, s67
v_and_b32 v88, v60, v8
v_and_b32 v89, v60, v9
v_and_b32 v90, v60, v10
v_and_b32 v91, v60, v11
s_nop 1
v_mfma_f32_16x16x32_bf16 v[56:59], v[184:187], v[88:91], v[56:59]
s_waitcnt vmcnt(13)
v_perm_b32 v60, v75, v75, s66
v_and_b32 v84, v60, v8
v_and_b32 v85, v60, v9
v_and_b32 v86, v60, v10
v_and_b32 v87, v60, v11
s_nop 1
v_mfma_f32_16x16x32_bf16 v[56:59], v[188:191], v[84:87], v[56:59]
s_waitcnt vmcnt(12)
v_perm_b32 v60, v75, v75, s67
v_and_b32 v88, v60, v8
v_and_b32 v89, v60, v9
v_and_b32 v90, v60, v10
v_and_b32 v91, v60, v11
s_nop 1
v_mfma_f32_16x16x32_bf16 v[56:59], v[192:195], v[88:91], v[56:59]
s_waitcnt vmcnt(11)
v_perm_b32 v60, v76, v76, s66
v_and_b32 v84, v60, v8
v_and_b32 v85, v60, v9
v_and_b32 v86, v60, v10
v_and_b32 v87, v60, v11
s_nop 1
v_mfma_f32_16x16x32_bf16 v[56:59], v[196:199], v[84:87], v[56:59]
s_waitcnt vmcnt(10)
v_perm_b32 v60, v76, v76, s67
v_and_b32 v88, v60, v8
v_and_b32 v89, v60, v9
v_and_b32 v90, v60, v10
v_and_b32 v91, v60, v11
s_nop 1
v_mfma_f32_16x16x32_bf16 v[56:59], v[200:203], v[88:91], v[56:59]
s_waitcnt vmcnt(9)
v_perm_b32 v60, v77, v77, s66
v_and_b32 v84, v60, v8
v_and_b32 v85, v60, v9
v_and_b32 v86, v60, v10
v_and_b32 v87, v60, v11
s_nop 1
v_mfma_f32_16x16x32_bf16 v[56:59], v[204:207], v[84:87], v[56:59]
s_waitcnt vmcnt(8)
v_perm_b32 v60, v77, v77, s67
v_and_b32 v88, v60, v8
v_and_b32 v89, v60, v9
v_and_b32 v90, v60, v10
v_and_b32 v91, v60, v11
s_nop 1
v_mfma_f32_16x16x32_bf16 v[56:59], v[208:211], v[88:91], v[56:59]
s_waitcnt vmcnt(7)
v_perm_b32 v60, v78, v78, s66
v_and_b32 v84, v60, v8
v_and_b32 v85, v60, v9
v_and_b32 v86, v60, v10
v_and_b32 v87, v60, v11
s_nop 1
v_mfma_f32_16x16x32_bf16 v[56:59], v[212:215], v[84:87], v[56:59]
s_waitcnt vmcnt(6)
v_perm_b32 v60, v78, v78, s67
v_and_b32 v88, v60, v8
v_and_b32 v89, v60, v9
v_and_b32 v90, v60, v10
v_and_b32 v91, v60, v11
s_nop 1
v_mfma_f32_16x16x32_bf16 v[56:59], v[216:219], v[88:91], v[56:59]
s_waitcnt vmcnt(5)
v_perm_b32 v60, v79, v79, s66
v_and_b32 v84, v60, v8
v_and_b32 v85, v60, v9
v_and_b32 v86, v60, v10
v_and_b32 v87, v60, v11
s_nop 1
v_mfma_f32_16x16x32_bf16 v[56:59], v[220:223], v[84:87], v[56:59]
s_waitcnt vmcnt(4)
v_perm_b32 v60, v79, v79, s67
v_and_b32 v88, v60, v8
v_and_b32 v89, v60, v9
v_and_b32 v90, v60, v10
v_and_b32 v91, v60, v11
s_nop 1
v_mfma_f32_16x16x32_bf16 v[56:59], v[224:227], v[88:91], v[56:59]
s_waitcnt vmcnt(3)
v_perm_b32 v60, v80, v80, s66
v_and_b32 v84, v60, v8
v_and_b32 v85, v60, v9
v_and_b32 v86, v60, v10
v_and_b32 v87, v60, v11
s_nop 1
v_mfma_f32_16x16x32_bf16 v[56:59], v[228:231], v[84:87], v[56:59]
s_waitcnt vmcnt(2)
v_perm_b32 v60, v80, v80, s67
v_and_b32 v88, v60, v8
v_and_b32 v89, v60, v9
v_and_b32 v90, v60, v10
v_and_b32 v91, v60, v11
s_nop 1
v_mfma_f32_16x16x32_bf16 v[56:59], v[232:235], v[88:91], v[56:59]
s_waitcnt vmcnt(1)
v_perm_b32 v60, v81, v81, s66
v_and_b32 v84, v60, v8
v_and_b32 v85, v60, v9
v_and_b32 v86, v60, v10
v_and_b32 v87, v60, v11
s_nop 1
v_mfma_f32_16x16x32_bf16 v[56:59], v[236:239], v[84:87], v[56:59]
s_waitcnt vmcnt(0)
v_perm_b32 v60, v81, v81, s67
v_and_b32 v88, v60, v8
v_and_b32 v89, v60, v9
v_and_b32 v90, v60, v10
v_and_b32 v91, v60, v11
s_nop 1
v_mfma_f32_16x16x32_bf16 v[56:59], v[240:243], v[88:91], v[56:59]
s_mov_b32 s30, s95
v_mov_b32 v60, 0
L_np:
v_readfirstlane_b32 s31, v61
s_cmp_lg_u32 s31, 0
s_cbranch_scc1 L_nok
s_sub_u32 s30, s30, 1
s_cbranch_scc1 L_nok
global_load_dword v61, v60, s[62:63] sc1
s_waitcnt vmcnt(0)
s_branch L_np
L_nok:
v_cmp_gt_u32 vcc, 8, v2
v_mov_b32 v65, s31
v_mov_b32 v67, s31
v_cndmask_b32 v64, v58, v56, vcc
v_cndmask_b32 v66, v59, v57, vcc
v_and_b32 v14, 7, v0
v_lshl_add_u32 v14, v3, 3, v14
v_lshrrev_b32 v15, 3, v2
v_lshl_add_u32 v14, v15, 5, v14
v_lshlrev_b32 v14, 4, v14
s_lshl_b32 s28, s2, 10
buffer_store_dwordx4 v[64:67], v14, s[12:15], s28 offen sc1
s_and_b32 s28, s2, 7
s_cbranch_scc1 L_ci32
s_and_b32 s29, s31, 0xfffff000
s_lshl_b32 s28, s34, 8
s_add_u32 s28, s28, 802816
v_mov_b32 v15, s29
s_mov_b64 exec, 1
buffer_store_dword v15, v60, s[12:15], s28 offen sc1
s_mov_b64 exec, -1
L_ci32:
s_and_b32 s28, s2, 15
s_cbranch_scc1 L_ci33
s_and_b32 s29, s31, 0xfffff000
s_lshl_b32 s28, s35, 8
s_add_u32 s28, s28, 802816
v_mov_b32 v15, s29
s_mov_b64 exec, 1
buffer_store_dword v15, v60, s[12:15], s28 offen sc1
s_mov_b64 exec, -1
L_ci33:
s_lshl_b32 s80, s34, 12
s_lshl_b32 s81, s35, 1
s_sub_u32 s81, s81, 32
s_lshl_b32 s81, s81, 12
s_add_u32 s82, s81, 4096
s_mov_b32 s30, s95
L_qp:
buffer_load_dwordx4 v[100:103], v5, s[12:15], s80 offen offset:0 sc1
buffer_load_dwordx4 v[104:107], v5, s[12:15], s80 offen offset:1024 sc1
buffer_load_dwordx4 v[108:111], v5, s[12:15], s80 offen offset:2048 sc1
buffer_load_dwordx4 v[112:115], v5, s[12:15], s80 offen offset:3072 sc1
buffer_load_dwordx4 v[116:119], v5, s[12:15], s81 offen offset:0 sc1
buffer_load_dwordx4 v[120:123], v5, s[12:15], s81 offen offset:1024 sc1
buffer_load_dwordx4 v[124:127], v5, s[12:15], s81 offen offset:2048 sc1
buffer_load_dwordx4 v[128:131], v5, s[12:15], s81 offen offset:3072 sc1
buffer_load_dwordx4 v[132:135], v5, s[12:15], s82 offen offset:0 sc1
buffer_load_dwordx4 v[136:139], v5, s[12:15], s82 offen offset:1024 sc1
buffer_load_dwordx4 v[140:143], v5, s[12:15], s82 offen offset:2048 sc1
buffer_load_dwordx4 v[144:147], v5, s[12:15], s82 offen offset:3072 sc1
s_waitcnt vmcnt(0)
v_mov_b32 v14, s31
v_mov_b32 v15, s31
v_min3_u32 v14, v14, v101, v103
v_max3_u32 v15, v15, v101, v103
v_min3_u32 v14, v14, v105, v107
v_max3_u32 v15, v15, v105, v107
v_min3_u32 v14, v14, v109, v111
v_max3_u32 v15, v15, v109, v111
v_min3_u32 v14, v14, v113, v115
v_max3_u32 v15, v15, v113, v115
v_min3_u32 v14, v14, v117, v119
v_max3_u32 v15, v15, v117, v119
v_min3_u32 v14, v14, v121, v123
v_max3_u32 v15, v15, v121, v123
v_min3_u32 v14, v14, v125, v127
v_max3_u32 v15, v15, v125, v127
v_min3_u32 v14, v14, v129, v131
v_max3_u32 v15, v15, v129, v131
v_min3_u32 v14, v14, v133, v135
v_max3_u32 v15, v15, v133, v135
v_min3_u32 v14, v14, v137, v139
v_max3_u32 v15, v15, v137, v139
v_min3_u32 v14, v14, v141, v143
v_max3_u32 v15, v15, v141, v143
v_min3_u32 v14, v14, v145, v147
v_max3_u32 v15, v15, v145, v147
v_cmp_ne_u32 vcc, v14, v15
s_nop 1
s_cbranch_vccz L_qok
s_sub_u32 s30, s30, 1
s_cbranch_scc1 L_qok
s_sleep 2
s_branch L_qp
L_qok:
v_and_b32 v14, 7, v0
v_bfe_u32 v15, v0, 3, 2
v_lshl_add_u32 v14, v15, 5, v14
v_lshrrev_b32 v15, 5, v0
v_lshl_add_u32 v62, v15, 4, v14
v_lshlrev_b32 v62, 1, v62
v_add_f32 v100, v100, v104
v_add_f32 v100, v100, v108
v_add_f32 v100, v100, v112
v_add_f32 v102, v102, v106
v_add_f32 v102, v102, v110
v_add_f32 v102, v102, v114
v_cvt_pk_bf16_f32 v100, v100, v102
ds_write_b16 v62, v100 offset:0
ds_write_b16_d16_hi v62, v100 offset:16
v_add_f32 v116, v116, v120
v_add_f32 v116, v116, v124
v_add_f32 v116, v116, v128
v_add_f32 v118, v118, v122
v_add_f32 v118, v118, v126
v_add_f32 v118, v118, v130
v_cvt_pk_bf16_f32 v116, v116, v118
ds_write_b16 v62, v116 offset:256
ds_write_b16_d16_hi v62, v116 offset:272
v_add_f32 v132, v132, v136
v_add_f32 v132, v132, v140
v_add_f32 v132, v132, v144
v_add_f32 v134, v134, v138
v_add_f32 v134, v134, v142
v_add_f32 v134, v134, v146
v_cvt_pk_bf16_f32 v132, v132, v134
ds_write_b16 v62, v132 offset:512
ds_write_b16_d16_hi v62, v132 offset:528
v_mov_b32 v14, 1024
v_mov_b32 v15, s31
ds_write_b32 v14, v15
v_mov_b32 v60, 0
ds_write_b32 v14, v60 offset:4
s_waitcnt lgkmcnt(0)
s_barrier
s_mov_b32 s33, s2
s_barrier
s_mul_i32 s28, s33, 7282
s_lshr_b32 s28, s28, 16
s_mul_i32 s29, s28, 9
s_sub_u32 s32, s33, s29
s_mov_b32 s33, s28
s_cmp_ge_u32 s33, 32
s_cselect_b32 s16, s58, s48
s_cselect_b32 s17, s59, s49
s_and_b32 s17, s17, 0xffff
s_and_b32 s28, s33, 31
s_mul_i32 s28, s28, 147456
s_lshl_b32 s29, s32, 7
s_add_u32 s28, s28, s29
v_lshrrev_b32 v14, 3, v0
v_mul_u32_u24 v14, 18432, v14
v_and_b32 v15, 7, v0
v_lshl_add_u32 v14, v15, 4, v14
buffer_load_dwordx4 a[0:3], v14, s[16:19], s28 offen offset:0 nt
buffer_load_dwordx4 a[4:7], v14, s[16:19], s28 offen offset:1152 nt
buffer_load_dwordx4 a[8:11], v14, s[16:19], s28 offen offset:2304 nt
buffer_load_dwordx4 a[12:15], v14, s[16:19], s28 offen offset:3456 nt
s_add_u32 s28, s28, 4608
buffer_load_dwordx4 a[16:19], v14, s[16:19], s28 offen offset:0 nt
buffer_load_dwordx4 a[20:23], v14, s[16:19], s28 offen offset:1152 nt
buffer_load_dwordx4 a[24:27], v14, s[16:19], s28 offen offset:2304 nt
buffer_load_dwordx4 a[28:31], v14, s[16:19], s28 offen offset:3456 nt
s_add_u32 s28, s28, 4608
buffer_load_dwordx4 a[32:35], v14, s[16:19], s28 offen offset:0 nt
buffer_load_dwordx4 a[36:39], v14, s[16:19], s28 offen offset:1152 nt
buffer_load_dwordx4 a[40:43], v14, s[16:19], s28 offen offset:2304 nt
buffer_load_dwordx4 a[44:47], v14, s[16:19], s28 offen offset:3456 nt
s_add_u32 s28, s28, 4608
buffer_load_dwordx4 a[48:51], v14, s[16:19], s28 offen offset:0 nt
buffer_load_dwordx4 a[52:55], v14, s[16:19], s28 offen offset:1152 nt
buffer_load_dwordx4 a[56:59], v14, s[16:19], s28 offen offset:2304 nt
buffer_load_dwordx4 a[60:63], v14, s[16:19], s28 offen offset:3456 nt
L_task:
s_lshl_b32 s28, s33, 8
s_add_u32 s28, s28, 786432
v_lshlrev_b32 v60, 4, v2
s_mov_b32 s30, s95
s_cmp_ge_u32 s33, 32
s_cselect_b64 s[88:89], -1, 0
s_cselect_b32 s26, 0, 1376256
s_add_u32 s26, s26, 4096
s_or_b32 s88, s88, 0x00ff00ff
s_or_b32 s89, s89, 0x00ff00ff
v_mov_b32 v70, s31
v_mov_b32 v71, 0xff800000
L_tp:
buffer_load_dwordx4 v[64:67], v60, s[12:15], s28 offen sc1
s_waitcnt vmcnt(0)
v_cndmask_b32 v64, v71, v64, s[88:89]
v_cndmask_b32 v65, v70, v65, s[88:89]
v_cndmask_b32 v66, 0, v66, s[88:89]
v_cndmask_b32 v67, v70, v67, s[88:89]
v_cmp_eq_u32 vcc, s31, v67
s_nop 1
s_and_b32 s27, vcc_lo, 0xffff
s_bcnt1_i32_b32 s27, s27
s_cmp_ge_u32 s27, 14
s_cbranch_scc1 L_tq0
s_sub_u32 s30, s30, 1
s_cbranch_scc1 L_tq0
s_sleep 2
s_branch L_tp
L_tq0:
s_mov_b32 s30, s95
L_tq:
buffer_load_dwordx4 v[64:67], v60, s[12:15], s28 offen sc1
s_lshl_b32 s29, s33, 13
s_add_u32 s29, s29, 262144
buffer_load_dwordx4 v[100:103], v5, s[12:15], s29 offen offset:0 sc1
buffer_load_dwordx4 v[104:107], v5, s[12:15], s29 offen offset:1024 sc1
buffer_load_dwordx4 v[108:111], v5, s[12:15], s29 offen offset:2048 sc1
buffer_load_dwordx4 v[112:115], v5, s[12:15], s29 offen offset:3072 sc1
s_add_u32 s29, s29, s26
buffer_load_dwordx4 v[116:119], v5, s[12:15], s29 offen offset:0 sc1
buffer_load_dwordx4 v[120:123], v5, s[12:15], s29 offen offset:1024 sc1
buffer_load_dwordx4 v[124:127], v5, s[12:15], s29 offen offset:2048 sc1
buffer_load_dwordx4 v[128:131], v5, s[12:15], s29 offen offset:3072 sc1
s_waitcnt vmcnt(8)
v_cndmask_b32 v64, v71, v64, s[88:89]
v_cndmask_b32 v65, v70, v65, s[88:89]
v_cndmask_b32 v66, 0, v66, s[88:89]
v_cndmask_b32 v67, v70, v67, s[88:89]
v_mov_b32 v68, v64
s_nop 1
v_max_f32_dpp v68, v68, v68 quad_perm:[1,0,3,2] row_mask:0xf bank_mask:0xf
s_nop 1
v_max_f32_dpp v68, v68, v68 quad_perm:[2,3,0,1] row_mask:0xf bank_mask:0xf
s_nop 1
v_max_f32_dpp v68, v68, v68 row_half_mirror row_mask:0xf bank_mask:0xf
s_nop 1
v_max_f32_dpp v68, v68, v68 row_ror:8 row_mask:0xf bank_mask:0xf
v_sub_f32 v69, v64, v68
v_exp_f32 v69, v69
s_nop 0
v_mul_f32 v68, v66, v69
s_nop 1
v_add_f32_dpp v68, v68, v68 quad_perm:[1,0,3,2] row_mask:0xf bank_mask:0xf
s_nop 1
v_add_f32_dpp v68, v68, v68 quad_perm:[2,3,0,1] row_mask:0xf bank_mask:0xf
s_nop 1
v_add_f32_dpp v68, v68, v68 row_half_mirror row_mask:0xf bank_mask:0xf
s_nop 1
v_add_f32_dpp v68, v68, v68 row_ror:8 row_mask:0xf bank_mask:0xf
v_rcp_f32 v68, v68
v_cmp_gt_u32 vcc, 32, v0
v_mul_f32 v69, v69, v68
s_nop 1
v_mov_b32_dpp v68, v69 quad_perm:[1,0,3,2] row_mask:0xf bank_mask:0xf
v_cndmask_b32 v69, v68, v69, vcc
v_and_b32 v15, 7, v0
v_bfe_u32 v14, v0, 3, 2
v_lshl_add_u32 v15, v14, 5, v15
v_lshrrev_b32 v14, 5, v0
v_lshl_add_u32 v62, v14, 4, v15
v_lshlrev_b32 v62, 1, v62
s_lshl_b32 s27, s3, 8
s_add_u32 s27, s27, 1280
v_add_u32 v63, s27, v62
s_waitcnt vmcnt(0)
v_max3_u32 v68, v100, v101, v102
v_max3_u32 v68, v68, v103, v104
v_max3_u32 v68, v68, v105, v106
v_max3_u32 v68, v68, v107, v108
v_max3_u32 v68, v68, v109, v110
v_max3_u32 v68, v68, v111, v112
v_max3_u32 v68, v68, v113, v114
v_max3_u32 v68, v68, v115, v116
v_max3_u32 v68, v68, v117, v118
v_max3_u32 v68, v68, v119, v120
v_max3_u32 v68, v68, v121, v122
v_max3_u32 v68, v68, v123, v124
v_max3_u32 v68, v68, v125, v126
v_max3_u32 v68, v68, v127, v128
v_max3_u32 v68, v68, v129, v130
v_max3_u32 v68, v68, v131, v131
v_cmp_ne_u32 vcc, s31, v65
v_xor_b32 v14, s31, v67
v_cmp_ne_u32 s[36:37], 0, v14
s_nop 1
v_cndmask_b32 v68, v68, -1, vcc
v_cndmask_b32 v68, v68, -1, s[36:37]
v_cmp_eq_u32 vcc, -1, v68
s_nop 1
s_cbranch_vccz L_tok
s_sub_u32 s30, s30, 1
s_cbranch_scc0 L_tq
L_tok:
v_mul_f32_dpp v72, v69, v100 row_newbcast:0 row_mask:0xf bank_mask:0xf
v_mul_f32_dpp v73, v69, v101 row_newbcast:0 row_mask:0xf bank_mask:0xf
v_mul_f32_dpp v74, v69, v102 row_newbcast:0 row_mask:0xf bank_mask:0xf
v_mul_f32_dpp v75, v69, v103 row_newbcast:0 row_mask:0xf bank_mask:0xf
v_fmac_f32_dpp v72, v69, v104 row_newbcast:2 row_mask:0xf bank_mask:0xf
v_fmac_f32_dpp v73, v69, v105 row_newbcast:2 row_mask:0xf bank_mask:0xf
v_fmac_f32_dpp v74, v69, v106 row_newbcast:2 row_mask:0xf bank_mask:0xf
v_fmac_f32_dpp v75, v69, v107 row_newbcast:2 row_mask:0xf bank_mask:0xf
v_fmac_f32_dpp v72, v69, v108 row_newbcast:4 row_mask:0xf bank_mask:0xf
v_fmac_f32_dpp v73, v69, v109 row_newbcast:4 row_mask:0xf bank_mask:0xf
v_fmac_f32_dpp v74, v69, v110 row_newbcast:4 row_mask:0xf bank_mask:0xf
v_fmac_f32_dpp v75, v69, v111 row_newbcast:4 row_mask:0xf bank_mask:0xf
v_fmac_f32_dpp v72, v69, v112 row_newbcast:6 row_mask:0xf bank_mask:0xf
v_fmac_f32_dpp v73, v69, v113 row_newbcast:6 row_mask:0xf bank_mask:0xf
v_fmac_f32_dpp v74, v69, v114 row_newbcast:6 row_mask:0xf bank_mask:0xf
v_fmac_f32_dpp v75, v69, v115 row_newbcast:6 row_mask:0xf bank_mask:0xf
v_fmac_f32_dpp v72, v69, v116 row_newbcast:8 row_mask:0xf bank_mask:0xf
v_fmac_f32_dpp v73, v69, v117 row_newbcast:8 row_mask:0xf bank_mask:0xf
v_fmac_f32_dpp v74, v69, v118 row_newbcast:8 row_mask:0xf bank_mask:0xf
v_fmac_f32_dpp v75, v69, v119 row_newbcast:8 row_mask:0xf bank_mask:0xf
v_fmac_f32_dpp v72, v69, v120 row_newbcast:10 row_mask:0xf bank_mask:0xf
v_fmac_f32_dpp v73, v69, v121 row_newbcast:10 row_mask:0xf bank_mask:0xf
v_fmac_f32_dpp v74, v69, v122 row_newbcast:10 row_mask:0xf bank_mask:0xf
v_fmac_f32_dpp v75, v69, v123 row_newbcast:10 row_mask:0xf bank_mask:0xf
v_fmac_f32_dpp v72, v69, v124 row_newbcast:12 row_mask:0xf bank_mask:0xf
v_fmac_f32_dpp v73, v69, v125 row_newbcast:12 row_mask:0xf bank_mask:0xf
v_fmac_f32_dpp v74, v69, v126 row_newbcast:12 row_mask:0xf bank_mask:0xf
v_fmac_f32_dpp v75, v69, v127 row_newbcast:12 row_mask:0xf bank_mask:0xf
v_fmac_f32_dpp v72, v69, v128 row_newbcast:14 row_mask:0xf bank_mask:0xf
v_fmac_f32_dpp v73, v69, v129 row_newbcast:14 row_mask:0xf bank_mask:0xf
v_fmac_f32_dpp v74, v69, v130 row_newbcast:14 row_mask:0xf bank_mask:0xf
v_fmac_f32_dpp v75, v69, v131 row_newbcast:14 row_mask:0xf bank_mask:0xf
s_nop 1
v_permlane32_swap_b32 v72, v74
v_permlane32_swap_b32 v73, v75
v_add_f32 v72, v72, v74
v_add_f32 v73, v73, v75
v_cvt_pk_bf16_f32 v70, v72, v73
v_lshrrev_b32 v14, 3, v0
v_lshl_add_u32 v14, v14, 5, s27
ds_write_b16 v63, v70
ds_write_b16_d16_hi v63, v70 offset:16
s_waitcnt lgkmcnt(0)
ds_read_b128 v[72:75], v14
ds_read_b128 v[76:79], v14 offset:16
s_waitcnt lgkmcnt(0)
v_perm_b32 v60, v72, v72, s66
v_and_b32 v84, v60, v8
v_and_b32 v85, v60, v9
v_and_b32 v86, v60, v10
v_and_b32 v87, v60, v11
s_nop 1
v_mfma_f32_16x16x32_bf16 v[56:59], a[0:3], v[84:87], 0
v_perm_b32 v60, v72, v72, s67
v_and_b32 v88, v60, v8
v_and_b32 v89, v60, v9
v_and_b32 v90, v60, v10
v_and_b32 v91, v60, v11
s_nop 1
v_mfma_f32_16x16x32_bf16 v[56:59], a[4:7], v[88:91], v[56:59]
v_perm_b32 v60, v73, v73, s66
v_and_b32 v84, v60, v8
v_and_b32 v85, v60, v9
v_and_b32 v86, v60, v10
v_and_b32 v87, v60, v11
s_nop 1
v_mfma_f32_16x16x32_bf16 v[56:59], a[8:11], v[84:87], v[56:59]
v_perm_b32 v60, v73, v73, s67
v_and_b32 v88, v60, v8
v_and_b32 v89, v60, v9
v_and_b32 v90, v60, v10
v_and_b32 v91, v60, v11
s_nop 1
v_mfma_f32_16x16x32_bf16 v[56:59], a[12:15], v[88:91], v[56:59]
v_perm_b32 v60, v74, v74, s66
v_and_b32 v84, v60, v8
v_and_b32 v85, v60, v9
v_and_b32 v86, v60, v10
v_and_b32 v87, v60, v11
s_nop 1
v_mfma_f32_16x16x32_bf16 v[56:59], a[16:19], v[84:87], v[56:59]
v_perm_b32 v60, v74, v74, s67
v_and_b32 v88, v60, v8
v_and_b32 v89, v60, v9
v_and_b32 v90, v60, v10
v_and_b32 v91, v60, v11
s_nop 1
v_mfma_f32_16x16x32_bf16 v[56:59], a[20:23], v[88:91], v[56:59]
v_perm_b32 v60, v75, v75, s66
v_and_b32 v84, v60, v8
v_and_b32 v85, v60, v9
v_and_b32 v86, v60, v10
v_and_b32 v87, v60, v11
s_nop 1
v_mfma_f32_16x16x32_bf16 v[56:59], a[24:27], v[84:87], v[56:59]
v_perm_b32 v60, v75, v75, s67
v_and_b32 v88, v60, v8
v_and_b32 v89, v60, v9
v_and_b32 v90, v60, v10
v_and_b32 v91, v60, v11
s_nop 1
v_mfma_f32_16x16x32_bf16 v[56:59], a[28:31], v[88:91], v[56:59]
v_perm_b32 v60, v76, v76, s66
v_and_b32 v84, v60, v8
v_and_b32 v85, v60, v9
v_and_b32 v86, v60, v10
v_and_b32 v87, v60, v11
s_nop 1
v_mfma_f32_16x16x32_bf16 v[56:59], a[32:35], v[84:87], v[56:59]
v_perm_b32 v60, v76, v76, s67
v_and_b32 v88, v60, v8
v_and_b32 v89, v60, v9
v_and_b32 v90, v60, v10
v_and_b32 v91, v60, v11
s_nop 1
v_mfma_f32_16x16x32_bf16 v[56:59], a[36:39], v[88:91], v[56:59]
v_perm_b32 v60, v77, v77, s66
v_and_b32 v84, v60, v8
v_and_b32 v85, v60, v9
v_and_b32 v86, v60, v10
v_and_b32 v87, v60, v11
s_nop 1
v_mfma_f32_16x16x32_bf16 v[56:59], a[40:43], v[84:87], v[56:59]
v_perm_b32 v60, v77, v77, s67
v_and_b32 v88, v60, v8
v_and_b32 v89, v60, v9
v_and_b32 v90, v60, v10
v_and_b32 v91, v60, v11
s_nop 1
v_mfma_f32_16x16x32_bf16 v[56:59], a[44:47], v[88:91], v[56:59]
v_perm_b32 v60, v78, v78, s66
v_and_b32 v84, v60, v8
v_and_b32 v85, v60, v9
v_and_b32 v86, v60, v10
v_and_b32 v87, v60, v11
s_nop 1
v_mfma_f32_16x16x32_bf16 v[56:59], a[48:51], v[84:87], v[56:59]
v_perm_b32 v60, v78, v78, s67
v_and_b32 v88, v60, v8
v_and_b32 v89, v60, v9
v_and_b32 v90, v60, v10
v_and_b32 v91, v60, v11
s_nop 1
v_mfma_f32_16x16x32_bf16 v[56:59], a[52:55], v[88:91], v[56:59]
v_perm_b32 v60, v79, v79, s66
v_and_b32 v84, v60, v8
v_and_b32 v85, v60, v9
v_and_b32 v86, v60, v10
v_and_b32 v87, v60, v11
s_nop 1
v_mfma_f32_16x16x32_bf16 v[56:59], a[56:59], v[84:87], v[56:59]
v_perm_b32 v60, v79, v79, s67
v_and_b32 v88, v60, v8
v_and_b32 v89, v60, v9
v_and_b32 v90, v60, v10
v_and_b32 v91, v60, v11
s_nop 1
v_mfma_f32_16x16x32_bf16 v[56:59], a[60:63], v[88:91], v[56:59]
s_nop 7
v_mov_b32 v64, v56
v_mov_b32 v65, v57
v_mov_b32 v66, v58
v_mov_b32 v67, v59
s_nop 1
v_permlane32_swap_b32 v56, v64
v_permlane32_swap_b32 v57, v65
v_permlane32_swap_b32 v58, v66
v_permlane32_swap_b32 v59, v67
s_nop 1
v_add_f32_dpp v96, v64, v56 row_ror:8 row_mask:0xf bank_mask:0xf
v_mov_b32 v97, s31
v_add_f32_dpp v98, v65, v57 row_ror:8 row_mask:0xf bank_mask:0xf
v_mov_b32 v99, s31
v_add_f32_dpp v100, v66, v58 row_ror:8 row_mask:0xf bank_mask:0xf
v_mov_b32 v101, s31
v_add_f32_dpp v102, v67, v59 row_ror:8 row_mask:0xf bank_mask:0xf
v_mov_b32 v103, s31
s_lshr_b32 s28, s33, 5
s_mul_i32 s28, s28, 9
s_add_u32 s28, s28, s32
s_lshl_b32 s28, s28, 5
s_and_b32 s29, s33, 31
s_add_u32 s28, s28, s29
s_lshl_b32 s28, s28, 9
s_add_u32 s28, s28, 1048576
v_lshl_add_u32 v14, v3, 3, v2
v_lshlrev_b32 v14, 4, v14
s_mov_b32 s36, 0x00ff00ff
s_mov_b32 s37, 0
s_mov_b64 exec, s[36:37]
buffer_store_dwordx4 v[96:99], v14, s[12:15], s28 offen sc1
buffer_store_dwordx4 v[100:103], v14, s[12:15], s28 offen offset:256 sc1
s_mov_b64 exec, -1
s_cmp_eq_u32 s94, 1
s_cbranch_scc1 L_final2
s_branch L_fin
L_final:
s_cmp_ge_u32 s2, 72
s_cbranch_scc1 L_fin
L_final2:
s_lshr_b32 s24, s2, 2
s_and_b32 s25, s2, 3
s_lshl_b32 s80, s24, 14
s_lshl_b32 s28, s25, 7
s_add_u32 s80, s80, s28
s_add_u32 s80, s80, 1048576
s_add_u32 s81, s80, 4096
s_add_u32 s82, s80, 8192
s_add_u32 s83, s80, 12288
v_lshrrev_b32 v60, 3, v0
v_lshlrev_b32 v60, 9, v60
v_and_b32 v62, 7, v0
v_lshl_add_u32 v60, v62, 4, v60
v_lshlrev_b32 v62, 1, v62
s_mov_b32 s20, s60
s_and_b32 s21, s61, 0xffff
s_mov_b32 s22, 2304
s_lshl_b32 s24, s24, 7
s_and_b32 s28, s25, 1
s_lshl_b32 s28, s28, 6
s_add_u32 s24, s24, s28
s_lshr_b32 s28, s25, 1
s_lshl_b32 s28, s28, 5
s_add_u32 s24, s24, s28
s_mov_b32 s30, s95
L_fp:
buffer_load_dwordx4 v[100:103], v60, s[12:15], s80 offen sc1
buffer_load_dwordx4 v[104:107], v60, s[12:15], s81 offen sc1
buffer_load_dwordx4 v[108:111], v60, s[12:15], s82 offen sc1
buffer_load_dwordx4 v[112:115], v60, s[12:15], s83 offen sc1
s_waitcnt vmcnt(0)
v_mov_b32 v14, s31
v_mov_b32 v15, s31
v_min3_u32 v14, v14, v101, v103
v_max3_u32 v15, v15, v101, v103
v_min3_u32 v14, v14, v105, v107
v_max3_u32 v15, v15, v105, v107
v_min3_u32 v14, v14, v109, v111
v_max3_u32 v15, v15, v109, v111
v_min3_u32 v14, v14, v113, v115
v_max3_u32 v15, v15, v113, v115
v_cmp_ne_u32 vcc, v14, v15
s_nop 1
s_cbranch_vccz L_fok
s_sub_u32 s30, s30, 1
s_cbranch_scc1 L_fok
s_branch L_fp
L_fok:
v_add_f32 v100, v100, v104
v_add_f32 v108, v108, v112
v_add_f32 v100, v100, v108
v_add_f32 v102, v102, v106
v_add_f32 v110, v110, v114
v_add_f32 v102, v102, v110
s_nop 1
v_add_f32_dpp v100, v100, v100 row_ror:8 row_mask:0xf bank_mask:0xf
v_mov_b32 v14, v100
s_nop 1
v_permlane16_swap_b32 v100, v14
v_add_f32 v100, v100, v14
v_mov_b32 v14, v100
s_nop 1
v_permlane32_swap_b32 v100, v14
v_add_f32 v100, v100, v14
s_nop 1
v_add_f32_dpp v102, v102, v102 row_ror:8 row_mask:0xf bank_mask:0xf
v_mov_b32 v14, v102
s_nop 1
v_permlane16_swap_b32 v102, v14
v_add_f32 v102, v102, v14
v_mov_b32 v14, v102
s_nop 1
v_permlane32_swap_b32 v102, v14
v_add_f32 v102, v102, v14
v_cvt_pk_bf16_f32 v100, v100, v102
s_mov_b64 exec, 0xff
buffer_store_short v100, v62, s[20:23], s24 offen
buffer_store_short_d16_hi v100, v62, s[20:23], s24 offen offset:16
s_mov_b64 exec, -1
L_fin:
L_end:
s_endpgm
.section .rodata,"a"
.p2align 6
.amdhsa_kernel concat_heads__mha_block_cached__gqa_block_cached__decode_kernel
  .amdhsa_next_free_vgpr 512
  .amdhsa_next_free_sgpr 102
  .amdhsa_accum_offset 256
  .amdhsa_group_segment_fixed_size 0
  .amdhsa_kernarg_size 104
  .amdhsa_user_sgpr_count 2
  .amdhsa_user_sgpr_kernarg_segment_ptr 1
  .amdhsa_system_sgpr_workgroup_id_x 1
.end_amdhsa_kernel
```
